```python
import torch

def _softmax(x, axis=-1):
    return torch.softmax(x, dim=axis)
def _gelu(x):
    return torch.nn.functional.gelu(x, approximate="tanh")
def _silu(x):
    return torch.nn.functional.silu(x)
def _sigmoid(x):
    return torch.sigmoid(x)
def _layernorm(x, axis=-1, eps=1e-5):
    m = x.mean(dim=axis, keepdim=True)
    v = x.var(dim=axis, keepdim=True, unbiased=False)
    return (x - m) / torch.sqrt(v + eps)
def _scatter_add(tgt, idx, src, axis=0):
    return tgt.clone().index_add_(axis, idx, src)
def _segment_sum(src, seg, n):
    out = torch.zeros((n,) + src.shape[1:], dtype=src.dtype)
    return out.index_add_(0, seg, src)
def _pad(x, pw):
    flat = tuple(v for pair in reversed(pw) for v in pair)
    return torch.nn.functional.pad(x, flat)

kernel_name = 'interleave_layers__grouped_kv_mqa__mixer_channel_mlp__prompt'

def setup_inputs():

    _w = (lambda a: (lambda t: t.to(torch.bfloat16) if t.is_floating_point() else t)(torch.as_tensor(a)))
    def _A_setup():
        B, S, D, H = 1, 2048, 640, 32
        Dh = D // H
        return {
            "x": _w((lambda *s: torch.randn(*s, dtype=torch.bfloat16) * 0.05)(B, S, D)),
            "wq": _w((lambda *s: torch.randn(*s, dtype=torch.bfloat16) * 0.05)(D, H * Dh)),
            "wk": _w((lambda *s: torch.randn(*s, dtype=torch.bfloat16) * 0.05)(D, Dh)),
            "wv": _w((lambda *s: torch.randn(*s, dtype=torch.bfloat16) * 0.05)(D, Dh)),
            "wo": _w((lambda *s: torch.randn(*s, dtype=torch.bfloat16) * 0.05)(H * Dh, D)),
        }
    _A_in = _A_setup()

    def _B_setup():
        B, S, D, F = 1, 2048, 640, 1728
        return {
            "x": _w((lambda *s: torch.randn(*s, dtype=torch.bfloat16) * 0.05)(B, S, D)),
            "w1": _w((lambda *s: torch.randn(*s, dtype=torch.bfloat16) * 3.2)(D, F) * (D ** -0.5)),
            "b1": _w((lambda *s: torch.randn(*s, dtype=torch.bfloat16) * 0.8)(F)),
            "w2": _w((lambda *s: torch.randn(*s, dtype=torch.bfloat16) * 0.4)(F, D) * (F ** -0.5)),
            "b2": _w((lambda *s: torch.randn(*s, dtype=torch.bfloat16) * 0.4)(D)),
        }
    _B_in = _B_setup()

    return {
        "A_x": _A_in["x"],
        "A_wq": _A_in["wq"],
        "A_wk": _A_in["wk"],
        "A_wv": _A_in["wv"],
        "A_wo": _A_in["wo"],
        "B_x": _B_in["x"],
        "B_w1": _B_in["w1"],
        "B_b1": _B_in["b1"],
        "B_w2": _B_in["w2"],
        "B_b2": _B_in["b2"],
    }

def reference(A_x, A_wq, A_wk, A_wv, A_wo, B_x, B_w1, B_b1, B_w2, B_b2):
    def _A_ref(x, wq, wk, wv, wo):
        B, S, D = x.shape
        H = 32
        Dh = D // H
        q = (lambda x, *d: x.permute(*d))((x @ wq).reshape(B, S, H, Dh), 0, 2, 1, 3)
        k = x @ wk
        v = x @ wv
        scores = torch.einsum("bhqd,bkd->bhqk", q, k) * (Dh ** -0.5)
        p = _softmax(scores, axis=-1)
        o = torch.einsum("bhqk,bkd->bhqd", p, v)
        return (lambda x, *d: x.permute(*d))(o, 0, 2, 1, 3).reshape(B, S, H * Dh) @ wo

    def _B_ref(x, w1, b1, w2, b2):
        y = _layernorm(x, axis=-1)
        h = _gelu(torch.einsum("bsd,df->bsf", y, w1) + b1)
        return torch.einsum("bsf,fd->bsd", h, w2) + b2

    x = A_x
    x = x + _A_ref(_layernorm(x, axis=-1), A_wq, A_wk, A_wv, A_wo)
    x = x + _B_ref(_layernorm(x, axis=-1), B_w1, B_b1, B_w2, B_b2)
    x = x + _A_ref(_layernorm(x, axis=-1), A_wq, A_wk, A_wv, A_wo)
    x = x + _B_ref(_layernorm(x, axis=-1), B_w1, B_b1, B_w2, B_b2)
    return x
```

```asm
; @launch kernel=prep_kernel grid=(256,1,1) block=(256,1,1) lds=1024
; @launch kernel=main_kernel grid=(256,1,1) block=(512,1,1) lds=163840
.amdgcn_target "amdgcn-amd-amdhsa--gfx950"
.text
.globl prep_kernel
.p2align 8
.type prep_kernel,@function
prep_kernel:
s_cmp_ge_u32 s2, 256
s_cbranch_scc1 prep_kernel_exit
s_load_dwordx2 s[52:53], s[0:1], 0
s_load_dwordx2 s[4:5], s[0:1], 96
s_load_dwordx2 s[6:7], s[0:1], 8
s_load_dwordx4 s[24:27], s[0:1], 16
s_load_dwordx2 s[28:29], s[0:1], 32
s_load_dwordx2 s[30:31], s[0:1], 48
s_load_dwordx2 s[32:33], s[0:1], 64
v_and_b32 v1, 63, v0
v_lshrrev_b32 v2, 6, v0
s_nop 0
v_readfirstlane_b32 s34, v2
v_and_b32 v3, 15, v1
v_lshrrev_b32 v4, 4, v1
v_lshlrev_b32 v5, 4, v1
s_waitcnt lgkmcnt(0)
s_mov_b32 s8, s4
s_mov_b32 s9, s5
s_mov_b32 s10, 268435456
s_mov_b32 s11, 0x20000
s_mov_b32 s12, s52
s_mov_b32 s13, s53
s_mov_b32 s14, 2621440
s_mov_b32 s15, 0x20000
s_lshl_b32 s35, s2, 2
s_add_u32 s35, s35, s34
v_mul_u32_u24 v7, 1280, v3
v_lshl_add_u32 v7, v4, 4, v7
s_add_u32 s36, s35, 0
s_mul_i32 s37, s36, 3277
s_lshr_b32 s37, s37, 16
s_mul_i32 s38, s37, 20
s_sub_u32 s38, s36, s38
s_mul_i32 s39, s37, 20480
s_lshl_b32 s38, s38, 6
s_add_u32 s39, s39, s38
buffer_load_dwordx4 v[16:19], v7, s[12:15], s39 offen
s_lshl_b32 s54, s36, 10
s_add_u32 s54, s54, 34222080
s_add_u32 s36, s35, 1024
s_mul_i32 s37, s36, 3277
s_lshr_b32 s37, s37, 16
s_mul_i32 s38, s37, 20
s_sub_u32 s38, s36, s38
s_mul_i32 s39, s37, 20480
s_lshl_b32 s38, s38, 6
s_add_u32 s39, s39, s38
buffer_load_dwordx4 v[20:23], v7, s[12:15], s39 offen
s_lshl_b32 s55, s36, 10
s_add_u32 s55, s55, 34222080
s_add_u32 s36, s35, 2048
s_mul_i32 s37, s36, 3277
s_lshr_b32 s37, s37, 16
s_mul_i32 s38, s37, 20
s_sub_u32 s38, s36, s38
s_mul_i32 s39, s37, 20480
s_lshl_b32 s38, s38, 6
s_add_u32 s39, s39, s38
buffer_load_dwordx4 v[24:27], v7, s[12:15], s39 offen
s_lshl_b32 s56, s36, 10
s_add_u32 s56, s56, 34222080
s_mov_b32 s57, s35
s_cmp_ge_u32 s2, 252
s_cbranch_scc0 prep_go
s_waitcnt vmcnt(0)
buffer_store_dwordx4 v[16:19], v5, s[8:11], s54 offen
buffer_store_dwordx4 v[20:23], v5, s[8:11], s55 offen
s_cmp_lt_u32 s57, 512
s_cbranch_scc0 prep_xd0
buffer_store_dwordx4 v[24:27], v5, s[8:11], s56 offen
prep_xd0:
s_branch prep_done
prep_go:
s_cmp_lt_u32 s2, 40
s_cbranch_scc1 prep_wq
s_cmp_lt_u32 s2, 43
s_cbranch_scc1 prep_kv
s_cmp_lt_u32 s2, 151
s_cbranch_scc1 prep_w1
s_branch prep_plain
prep_wq:
s_mov_b32 s12, s6
s_mov_b32 s13, s7
s_mov_b32 s14, 819200
s_mov_b32 s15, 0x20000
s_mul_i32 s35, s2, 52429
s_lshr_b32 s35, s35, 18
s_mul_i32 s36, s35, 5
s_sub_u32 s36, s2, s36
v_mul_u32_u24 v7, 10240, v4
s_lshl_b32 s37, s2, 5
v_lshl_add_u32 v7, v3, 1, v7
v_add_u32 v7, s37, v7
s_mul_i32 s38, s34, 204800
s_add_u32 s40, s38, 0
buffer_load_ushort v64, v7, s[12:15], s40 offen
s_add_u32 s40, s38, 1280
buffer_load_ushort v65, v7, s[12:15], s40 offen
s_add_u32 s40, s38, 2560
buffer_load_ushort v66, v7, s[12:15], s40 offen
s_add_u32 s40, s38, 3840
buffer_load_ushort v67, v7, s[12:15], s40 offen
s_add_u32 s40, s38, 5120
buffer_load_ushort v68, v7, s[12:15], s40 offen
s_add_u32 s40, s38, 6400
buffer_load_ushort v69, v7, s[12:15], s40 offen
s_add_u32 s40, s38, 7680
buffer_load_ushort v70, v7, s[12:15], s40 offen
s_add_u32 s40, s38, 8960
buffer_load_ushort v71, v7, s[12:15], s40 offen
s_add_u32 s40, s38, 40960
buffer_load_ushort v72, v7, s[12:15], s40 offen
s_add_u32 s40, s38, 42240
buffer_load_ushort v73, v7, s[12:15], s40 offen
s_add_u32 s40, s38, 43520
buffer_load_ushort v74, v7, s[12:15], s40 offen
s_add_u32 s40, s38, 44800
buffer_load_ushort v75, v7, s[12:15], s40 offen
s_add_u32 s40, s38, 46080
buffer_load_ushort v76, v7, s[12:15], s40 offen
s_add_u32 s40, s38, 47360
buffer_load_ushort v77, v7, s[12:15], s40 offen
s_add_u32 s40, s38, 48640
buffer_load_ushort v78, v7, s[12:15], s40 offen
s_add_u32 s40, s38, 49920
buffer_load_ushort v79, v7, s[12:15], s40 offen
s_add_u32 s40, s38, 81920
buffer_load_ushort v80, v7, s[12:15], s40 offen
s_add_u32 s40, s38, 83200
buffer_load_ushort v81, v7, s[12:15], s40 offen
s_add_u32 s40, s38, 84480
buffer_load_ushort v82, v7, s[12:15], s40 offen
s_add_u32 s40, s38, 85760
buffer_load_ushort v83, v7, s[12:15], s40 offen
s_add_u32 s40, s38, 87040
buffer_load_ushort v84, v7, s[12:15], s40 offen
s_add_u32 s40, s38, 88320
buffer_load_ushort v85, v7, s[12:15], s40 offen
s_add_u32 s40, s38, 89600
buffer_load_ushort v86, v7, s[12:15], s40 offen
s_add_u32 s40, s38, 90880
buffer_load_ushort v87, v7, s[12:15], s40 offen
s_add_u32 s40, s38, 122880
buffer_load_ushort v88, v7, s[12:15], s40 offen
s_add_u32 s40, s38, 124160
buffer_load_ushort v89, v7, s[12:15], s40 offen
s_add_u32 s40, s38, 125440
buffer_load_ushort v90, v7, s[12:15], s40 offen
s_add_u32 s40, s38, 126720
buffer_load_ushort v91, v7, s[12:15], s40 offen
s_add_u32 s40, s38, 128000
buffer_load_ushort v92, v7, s[12:15], s40 offen
s_add_u32 s40, s38, 129280
buffer_load_ushort v93, v7, s[12:15], s40 offen
s_add_u32 s40, s38, 130560
buffer_load_ushort v94, v7, s[12:15], s40 offen
s_add_u32 s40, s38, 131840
buffer_load_ushort v95, v7, s[12:15], s40 offen
s_add_u32 s40, s38, 163840
buffer_load_ushort v96, v7, s[12:15], s40 offen
s_add_u32 s40, s38, 165120
buffer_load_ushort v97, v7, s[12:15], s40 offen
s_add_u32 s40, s38, 166400
buffer_load_ushort v98, v7, s[12:15], s40 offen
s_add_u32 s40, s38, 167680
buffer_load_ushort v99, v7, s[12:15], s40 offen
s_add_u32 s40, s38, 168960
buffer_load_ushort v100, v7, s[12:15], s40 offen
s_add_u32 s40, s38, 170240
buffer_load_ushort v101, v7, s[12:15], s40 offen
s_add_u32 s40, s38, 171520
buffer_load_ushort v102, v7, s[12:15], s40 offen
s_add_u32 s40, s38, 172800
buffer_load_ushort v103, v7, s[12:15], s40 offen
s_mul_i32 s44, s35, 788480
s_mul_i32 s45, s34, 25600
s_add_u32 s44, s44, s45
s_lshl_b32 s45, s36, 10
s_add_u32 s44, s44, s45
s_add_u32 s44, s44, 20480
s_mul_i32 s46, s35, 384
s_lshl_b32 s45, s36, 6
s_add_u32 s46, s46, s45
s_add_u32 s46, s46, 6324224
v_mov_b32 v132, 0x3f803f80
v_mov_b32 v133, 0x3f803f80
v_mov_b32 v134, 0x3f803f80
v_mov_b32 v135, 0x3f803f80
s_waitcnt vmcnt(0)
buffer_store_dwordx4 v[16:19], v5, s[8:11], s54 offen
buffer_store_dwordx4 v[20:23], v5, s[8:11], s55 offen
s_cmp_lt_u32 s57, 512
s_cbranch_scc0 prep_xd1
buffer_store_dwordx4 v[24:27], v5, s[8:11], s56 offen
prep_xd1:
v_lshl_or_b32 v32, v65, 16, v64
v_lshl_or_b32 v33, v67, 16, v66
v_lshl_or_b32 v34, v69, 16, v68
v_lshl_or_b32 v35, v71, 16, v70
v_lshl_or_b32 v36, v73, 16, v72
v_lshl_or_b32 v37, v75, 16, v74
v_lshl_or_b32 v38, v77, 16, v76
v_lshl_or_b32 v39, v79, 16, v78
v_lshl_or_b32 v40, v81, 16, v80
v_lshl_or_b32 v41, v83, 16, v82
v_lshl_or_b32 v42, v85, 16, v84
v_lshl_or_b32 v43, v87, 16, v86
v_lshl_or_b32 v44, v89, 16, v88
v_lshl_or_b32 v45, v91, 16, v90
v_lshl_or_b32 v46, v93, 16, v92
v_lshl_or_b32 v47, v95, 16, v94
v_lshl_or_b32 v48, v97, 16, v96
v_lshl_or_b32 v49, v99, 16, v98
v_lshl_or_b32 v50, v101, 16, v100
v_lshl_or_b32 v51, v103, 16, v102
s_add_u32 s40, s44, 0
buffer_store_dwordx4 v[32:35], v5, s[8:11], s40 offen
v_mfma_f32_16x16x32_bf16 v[28:31], v[32:35], v[132:135], 0
s_add_u32 s40, s44, 5120
buffer_store_dwordx4 v[36:39], v5, s[8:11], s40 offen
v_mfma_f32_16x16x32_bf16 v[28:31], v[36:39], v[132:135], v[28:31]
s_add_u32 s40, s44, 10240
buffer_store_dwordx4 v[40:43], v5, s[8:11], s40 offen
v_mfma_f32_16x16x32_bf16 v[28:31], v[40:43], v[132:135], v[28:31]
s_add_u32 s40, s44, 15360
buffer_store_dwordx4 v[44:47], v5, s[8:11], s40 offen
v_mfma_f32_16x16x32_bf16 v[28:31], v[44:47], v[132:135], v[28:31]
s_add_u32 s40, s44, 20480
buffer_store_dwordx4 v[48:51], v5, s[8:11], s40 offen
v_mfma_f32_16x16x32_bf16 v[28:31], v[48:51], v[132:135], v[28:31]
v_lshlrev_b32 v6, 4, v4
s_lshl_b32 s41, s34, 6
v_add_u32 v6, s41, v6
v_cmp_eq_u32 vcc, 0, v3
s_nop 2
s_and_saveexec_b64 s[42:43], vcc
ds_write_b128 v6, v[28:31]
s_mov_b64 exec, s[42:43]
s_waitcnt lgkmcnt(0)
s_barrier
v_lshlrev_b32 v6, 2, v0
v_cmp_gt_u32 vcc, 16, v0
s_nop 2
s_and_saveexec_b64 s[42:43], vcc
s_cbranch_execz prep_kernel_exit
ds_read_b32 v7, v6
ds_read_b32 v8, v6 offset:64
ds_read_b32 v9, v6 offset:128
ds_read_b32 v10, v6 offset:192
s_waitcnt lgkmcnt(0)
v_add_f32 v7, v7, v8
v_add_f32 v9, v9, v10
v_add_f32 v7, v7, v9
buffer_store_dword v7, v6, s[8:11], s46 offen
s_waitcnt vmcnt(0)
s_endpgm
prep_kv:
s_mov_b32 s12, s24
s_mov_b32 s13, s25
s_mov_b32 s14, 25600
s_mov_b32 s15, 0x20000
s_mov_b32 s16, s26
s_mov_b32 s17, s27
s_mov_b32 s18, 25600
s_mov_b32 s19, 0x20000
s_sub_u32 s35, s2, 40
v_mov_b32 v64, 0
v_mov_b32 v65, 0
v_mov_b32 v66, 0
v_mov_b32 v67, 0
v_mov_b32 v68, 0
v_mov_b32 v69, 0
v_mov_b32 v70, 0
v_mov_b32 v71, 0
v_mov_b32 v72, 0
v_mov_b32 v73, 0
v_mov_b32 v74, 0
v_mov_b32 v75, 0
v_mov_b32 v76, 0
v_mov_b32 v77, 0
v_mov_b32 v78, 0
v_mov_b32 v79, 0
v_mov_b32 v80, 0
v_mov_b32 v81, 0
v_mov_b32 v82, 0
v_mov_b32 v83, 0
v_mov_b32 v84, 0
v_mov_b32 v85, 0
v_mov_b32 v86, 0
v_mov_b32 v87, 0
v_mov_b32 v88, 0
v_mov_b32 v89, 0
v_mov_b32 v90, 0
v_mov_b32 v91, 0
v_mov_b32 v92, 0
v_mov_b32 v93, 0
v_mov_b32 v94, 0
v_mov_b32 v95, 0
v_mov_b32 v96, 0
v_mov_b32 v97, 0
v_mov_b32 v98, 0
v_mov_b32 v99, 0
v_mov_b32 v100, 0
v_mov_b32 v101, 0
v_mov_b32 v102, 0
v_mov_b32 v103, 0
v_and_b32 v8, 3, v3
v_lshrrev_b32 v9, 2, v3
s_cmp_eq_u32 s35, 0
s_cbranch_scc1 prep_kv0
s_cmp_eq_u32 s35, 1
s_cbranch_scc1 prep_kv1
v_mov_b32 v10, 1073741824
v_mov_b32 v11, 1073741824
v_lshlrev_b32 v12, 1, v3
v_add_u32 v12, 32, v12
v_cmp_gt_u32 vcc, 4, v3
s_nop 1
v_cndmask_b32 v10, v10, v12, vcc
v_lshlrev_b32 v12, 1, v8
v_add_u32 v13, 16, v12
v_add_u32 v14, 36, v12
v_cmp_eq_u32 vcc, 1, v9
s_nop 1
v_cndmask_b32 v11, v11, v13, vcc
v_cmp_eq_u32 vcc, 2, v9
s_nop 1
v_cndmask_b32 v11, v11, v14, vcc
v_mov_b32 v12, 1073741824
v_cmp_lt_u32 vcc, 1, v8
s_nop 1
v_cndmask_b32 v11, v11, v12, vcc
s_branch prep_kvgo
prep_kv0:
v_lshlrev_b32 v10, 1, v3
v_mov_b32 v11, 1073741824
s_branch prep_kvgo
prep_kv1:
v_mov_b32 v10, 1073741824
v_mov_b32 v11, 0
v_cmp_eq_u32 vcc, 1, v9
s_nop 1
v_cndmask_b32 v11, v11, 10, vcc
v_cmp_eq_u32 vcc, 2, v9
s_nop 1
v_cndmask_b32 v11, v11, 4, vcc
v_cmp_eq_u32 vcc, 3, v9
s_nop 1
v_cndmask_b32 v11, v11, 14, vcc
v_add_u32 v11, v11, v8
v_lshlrev_b32 v11, 1, v11
prep_kvgo:
v_mul_u32_u24 v12, 320, v4
v_add_u32 v10, v10, v12
v_add_u32 v11, v11, v12
s_mul_i32 s38, s34, 6400
v_cmp_gt_u32 vcc, 1073741824, v10
s_nop 2
s_and_saveexec_b64 s[48:49], vcc
s_cbranch_execz prep_kv_skipk
s_add_u32 s40, s38, 0
buffer_load_ushort v64, v10, s[12:15], s40 offen
s_add_u32 s40, s38, 40
buffer_load_ushort v65, v10, s[12:15], s40 offen
s_add_u32 s40, s38, 80
buffer_load_ushort v66, v10, s[12:15], s40 offen
s_add_u32 s40, s38, 120
buffer_load_ushort v67, v10, s[12:15], s40 offen
s_add_u32 s40, s38, 160
buffer_load_ushort v68, v10, s[12:15], s40 offen
s_add_u32 s40, s38, 200
buffer_load_ushort v69, v10, s[12:15], s40 offen
s_add_u32 s40, s38, 240
buffer_load_ushort v70, v10, s[12:15], s40 offen
s_add_u32 s40, s38, 280
buffer_load_ushort v71, v10, s[12:15], s40 offen
s_add_u32 s40, s38, 1280
buffer_load_ushort v72, v10, s[12:15], s40 offen
s_add_u32 s40, s38, 1320
buffer_load_ushort v73, v10, s[12:15], s40 offen
s_add_u32 s40, s38, 1360
buffer_load_ushort v74, v10, s[12:15], s40 offen
s_add_u32 s40, s38, 1400
buffer_load_ushort v75, v10, s[12:15], s40 offen
s_add_u32 s40, s38, 1440
buffer_load_ushort v76, v10, s[12:15], s40 offen
s_add_u32 s40, s38, 1480
buffer_load_ushort v77, v10, s[12:15], s40 offen
s_add_u32 s40, s38, 1520
buffer_load_ushort v78, v10, s[12:15], s40 offen
s_add_u32 s40, s38, 1560
buffer_load_ushort v79, v10, s[12:15], s40 offen
s_add_u32 s40, s38, 2560
buffer_load_ushort v80, v10, s[12:15], s40 offen
s_add_u32 s40, s38, 2600
buffer_load_ushort v81, v10, s[12:15], s40 offen
s_add_u32 s40, s38, 2640
buffer_load_ushort v82, v10, s[12:15], s40 offen
s_add_u32 s40, s38, 2680
buffer_load_ushort v83, v10, s[12:15], s40 offen
s_add_u32 s40, s38, 2720
buffer_load_ushort v84, v10, s[12:15], s40 offen
s_add_u32 s40, s38, 2760
buffer_load_ushort v85, v10, s[12:15], s40 offen
s_add_u32 s40, s38, 2800
buffer_load_ushort v86, v10, s[12:15], s40 offen
s_add_u32 s40, s38, 2840
buffer_load_ushort v87, v10, s[12:15], s40 offen
s_add_u32 s40, s38, 3840
buffer_load_ushort v88, v10, s[12:15], s40 offen
s_add_u32 s40, s38, 3880
buffer_load_ushort v89, v10, s[12:15], s40 offen
s_add_u32 s40, s38, 3920
buffer_load_ushort v90, v10, s[12:15], s40 offen
s_add_u32 s40, s38, 3960
buffer_load_ushort v91, v10, s[12:15], s40 offen
s_add_u32 s40, s38, 4000
buffer_load_ushort v92, v10, s[12:15], s40 offen
s_add_u32 s40, s38, 4040
buffer_load_ushort v93, v10, s[12:15], s40 offen
s_add_u32 s40, s38, 4080
buffer_load_ushort v94, v10, s[12:15], s40 offen
s_add_u32 s40, s38, 4120
buffer_load_ushort v95, v10, s[12:15], s40 offen
s_add_u32 s40, s38, 5120
buffer_load_ushort v96, v10, s[12:15], s40 offen
s_add_u32 s40, s38, 5160
buffer_load_ushort v97, v10, s[12:15], s40 offen
s_add_u32 s40, s38, 5200
buffer_load_ushort v98, v10, s[12:15], s40 offen
s_add_u32 s40, s38, 5240
buffer_load_ushort v99, v10, s[12:15], s40 offen
s_add_u32 s40, s38, 5280
buffer_load_ushort v100, v10, s[12:15], s40 offen
s_add_u32 s40, s38, 5320
buffer_load_ushort v101, v10, s[12:15], s40 offen
s_add_u32 s40, s38, 5360
buffer_load_ushort v102, v10, s[12:15], s40 offen
s_add_u32 s40, s38, 5400
buffer_load_ushort v103, v10, s[12:15], s40 offen
prep_kv_skipk:
s_mov_b64 exec, s[48:49]
v_cmp_gt_u32 vcc, 1073741824, v11
s_nop 2
s_and_saveexec_b64 s[48:49], vcc
s_cbranch_execz prep_kv_skipv
s_add_u32 s40, s38, 0
buffer_load_ushort v64, v11, s[16:19], s40 offen
s_add_u32 s40, s38, 40
buffer_load_ushort v65, v11, s[16:19], s40 offen
s_add_u32 s40, s38, 80
buffer_load_ushort v66, v11, s[16:19], s40 offen
s_add_u32 s40, s38, 120
buffer_load_ushort v67, v11, s[16:19], s40 offen
s_add_u32 s40, s38, 160
buffer_load_ushort v68, v11, s[16:19], s40 offen
s_add_u32 s40, s38, 200
buffer_load_ushort v69, v11, s[16:19], s40 offen
s_add_u32 s40, s38, 240
buffer_load_ushort v70, v11, s[16:19], s40 offen
s_add_u32 s40, s38, 280
buffer_load_ushort v71, v11, s[16:19], s40 offen
s_add_u32 s40, s38, 1280
buffer_load_ushort v72, v11, s[16:19], s40 offen
s_add_u32 s40, s38, 1320
buffer_load_ushort v73, v11, s[16:19], s40 offen
s_add_u32 s40, s38, 1360
buffer_load_ushort v74, v11, s[16:19], s40 offen
s_add_u32 s40, s38, 1400
buffer_load_ushort v75, v11, s[16:19], s40 offen
s_add_u32 s40, s38, 1440
buffer_load_ushort v76, v11, s[16:19], s40 offen
s_add_u32 s40, s38, 1480
buffer_load_ushort v77, v11, s[16:19], s40 offen
s_add_u32 s40, s38, 1520
buffer_load_ushort v78, v11, s[16:19], s40 offen
s_add_u32 s40, s38, 1560
buffer_load_ushort v79, v11, s[16:19], s40 offen
s_add_u32 s40, s38, 2560
buffer_load_ushort v80, v11, s[16:19], s40 offen
s_add_u32 s40, s38, 2600
buffer_load_ushort v81, v11, s[16:19], s40 offen
s_add_u32 s40, s38, 2640
buffer_load_ushort v82, v11, s[16:19], s40 offen
s_add_u32 s40, s38, 2680
buffer_load_ushort v83, v11, s[16:19], s40 offen
s_add_u32 s40, s38, 2720
buffer_load_ushort v84, v11, s[16:19], s40 offen
s_add_u32 s40, s38, 2760
buffer_load_ushort v85, v11, s[16:19], s40 offen
s_add_u32 s40, s38, 2800
buffer_load_ushort v86, v11, s[16:19], s40 offen
s_add_u32 s40, s38, 2840
buffer_load_ushort v87, v11, s[16:19], s40 offen
s_add_u32 s40, s38, 3840
buffer_load_ushort v88, v11, s[16:19], s40 offen
s_add_u32 s40, s38, 3880
buffer_load_ushort v89, v11, s[16:19], s40 offen
s_add_u32 s40, s38, 3920
buffer_load_ushort v90, v11, s[16:19], s40 offen
s_add_u32 s40, s38, 3960
buffer_load_ushort v91, v11, s[16:19], s40 offen
s_add_u32 s40, s38, 4000
buffer_load_ushort v92, v11, s[16:19], s40 offen
s_add_u32 s40, s38, 4040
buffer_load_ushort v93, v11, s[16:19], s40 offen
s_add_u32 s40, s38, 4080
buffer_load_ushort v94, v11, s[16:19], s40 offen
s_add_u32 s40, s38, 4120
buffer_load_ushort v95, v11, s[16:19], s40 offen
s_add_u32 s40, s38, 5120
buffer_load_ushort v96, v11, s[16:19], s40 offen
s_add_u32 s40, s38, 5160
buffer_load_ushort v97, v11, s[16:19], s40 offen
s_add_u32 s40, s38, 5200
buffer_load_ushort v98, v11, s[16:19], s40 offen
s_add_u32 s40, s38, 5240
buffer_load_ushort v99, v11, s[16:19], s40 offen
s_add_u32 s40, s38, 5280
buffer_load_ushort v100, v11, s[16:19], s40 offen
s_add_u32 s40, s38, 5320
buffer_load_ushort v101, v11, s[16:19], s40 offen
s_add_u32 s40, s38, 5360
buffer_load_ushort v102, v11, s[16:19], s40 offen
s_add_u32 s40, s38, 5400
buffer_load_ushort v103, v11, s[16:19], s40 offen
prep_kv_skipv:
s_mov_b64 exec, s[48:49]
s_mul_i32 s44, s35, 788480
s_mul_i32 s45, s34, 5120
s_add_u32 s44, s44, s45
s_add_u32 s44, s44, 0
s_mul_i32 s46, s35, 384
s_add_u32 s46, s46, 6324544
v_mov_b32 v132, 0x3f803f80
v_mov_b32 v133, 0x3f803f80
v_mov_b32 v134, 0x3f803f80
v_mov_b32 v135, 0x3f803f80
s_waitcnt vmcnt(0)
buffer_store_dwordx4 v[16:19], v5, s[8:11], s54 offen
buffer_store_dwordx4 v[20:23], v5, s[8:11], s55 offen
s_cmp_lt_u32 s57, 512
s_cbranch_scc0 prep_xd2
buffer_store_dwordx4 v[24:27], v5, s[8:11], s56 offen
prep_xd2:
v_lshl_or_b32 v32, v65, 16, v64
v_lshl_or_b32 v33, v67, 16, v66
v_lshl_or_b32 v34, v69, 16, v68
v_lshl_or_b32 v35, v71, 16, v70
v_lshl_or_b32 v36, v73, 16, v72
v_lshl_or_b32 v37, v75, 16, v74
v_lshl_or_b32 v38, v77, 16, v76
v_lshl_or_b32 v39, v79, 16, v78
v_lshl_or_b32 v40, v81, 16, v80
v_lshl_or_b32 v41, v83, 16, v82
v_lshl_or_b32 v42, v85, 16, v84
v_lshl_or_b32 v43, v87, 16, v86
v_lshl_or_b32 v44, v89, 16, v88
v_lshl_or_b32 v45, v91, 16, v90
v_lshl_or_b32 v46, v93, 16, v92
v_lshl_or_b32 v47, v95, 16, v94
v_lshl_or_b32 v48, v97, 16, v96
v_lshl_or_b32 v49, v99, 16, v98
v_lshl_or_b32 v50, v101, 16, v100
v_lshl_or_b32 v51, v103, 16, v102
s_add_u32 s40, s44, 0
buffer_store_dwordx4 v[32:35], v5, s[8:11], s40 offen
v_mfma_f32_16x16x32_bf16 v[28:31], v[32:35], v[132:135], 0
s_add_u32 s40, s44, 1024
buffer_store_dwordx4 v[36:39], v5, s[8:11], s40 offen
v_mfma_f32_16x16x32_bf16 v[28:31], v[36:39], v[132:135], v[28:31]
s_add_u32 s40, s44, 2048
buffer_store_dwordx4 v[40:43], v5, s[8:11], s40 offen
v_mfma_f32_16x16x32_bf16 v[28:31], v[40:43], v[132:135], v[28:31]
s_add_u32 s40, s44, 3072
buffer_store_dwordx4 v[44:47], v5, s[8:11], s40 offen
v_mfma_f32_16x16x32_bf16 v[28:31], v[44:47], v[132:135], v[28:31]
s_add_u32 s40, s44, 4096
buffer_store_dwordx4 v[48:51], v5, s[8:11], s40 offen
v_mfma_f32_16x16x32_bf16 v[28:31], v[48:51], v[132:135], v[28:31]
v_lshlrev_b32 v6, 4, v4
s_lshl_b32 s41, s34, 6
v_add_u32 v6, s41, v6
v_cmp_eq_u32 vcc, 0, v3
s_nop 2
s_and_saveexec_b64 s[42:43], vcc
ds_write_b128 v6, v[28:31]
s_mov_b64 exec, s[42:43]
s_waitcnt lgkmcnt(0)
s_barrier
v_lshlrev_b32 v6, 2, v0
v_cmp_gt_u32 vcc, 16, v0
s_nop 2
s_and_saveexec_b64 s[42:43], vcc
s_cbranch_execz prep_kernel_exit
ds_read_b32 v7, v6
ds_read_b32 v8, v6 offset:64
ds_read_b32 v9, v6 offset:128
ds_read_b32 v10, v6 offset:192
s_waitcnt lgkmcnt(0)
v_add_f32 v7, v7, v8
v_add_f32 v9, v9, v10
v_add_f32 v7, v7, v9
buffer_store_dword v7, v6, s[8:11], s46 offen
s_waitcnt vmcnt(0)
s_endpgm
prep_w1:
s_mov_b32 s12, s30
s_mov_b32 s13, s31
s_mov_b32 s14, 2211840
s_mov_b32 s15, 0x20000
s_sub_u32 s35, s2, 43
s_mul_i32 s36, s35, 2428
s_lshr_b32 s36, s36, 16
s_mul_i32 s37, s36, 27
s_sub_u32 s37, s35, s37
s_lshl_b32 s36, s36, 1
s_cmp_ge_u32 s37, 14
s_cbranch_scc0 prep_w1a
s_add_u32 s36, s36, 1
s_sub_u32 s37, s37, 14
prep_w1a:
v_mul_u32_u24 v7, 27648, v4
s_lshl_b32 s39, s35, 5
v_lshl_add_u32 v7, v3, 1, v7
v_add_u32 v7, s39, v7
s_mul_i32 s38, s34, 552960
s_add_u32 s40, s38, 0
buffer_load_ushort v64, v7, s[12:15], s40 offen
s_add_u32 s40, s38, 3456
buffer_load_ushort v65, v7, s[12:15], s40 offen
s_add_u32 s40, s38, 6912
buffer_load_ushort v66, v7, s[12:15], s40 offen
s_add_u32 s40, s38, 10368
buffer_load_ushort v67, v7, s[12:15], s40 offen
s_add_u32 s40, s38, 13824
buffer_load_ushort v68, v7, s[12:15], s40 offen
s_add_u32 s40, s38, 17280
buffer_load_ushort v69, v7, s[12:15], s40 offen
s_add_u32 s40, s38, 20736
buffer_load_ushort v70, v7, s[12:15], s40 offen
s_add_u32 s40, s38, 24192
buffer_load_ushort v71, v7, s[12:15], s40 offen
s_add_u32 s40, s38, 110592
buffer_load_ushort v72, v7, s[12:15], s40 offen
s_add_u32 s40, s38, 114048
buffer_load_ushort v73, v7, s[12:15], s40 offen
s_add_u32 s40, s38, 117504
buffer_load_ushort v74, v7, s[12:15], s40 offen
s_add_u32 s40, s38, 120960
buffer_load_ushort v75, v7, s[12:15], s40 offen
s_add_u32 s40, s38, 124416
buffer_load_ushort v76, v7, s[12:15], s40 offen
s_add_u32 s40, s38, 127872
buffer_load_ushort v77, v7, s[12:15], s40 offen
s_add_u32 s40, s38, 131328
buffer_load_ushort v78, v7, s[12:15], s40 offen
s_add_u32 s40, s38, 134784
buffer_load_ushort v79, v7, s[12:15], s40 offen
s_add_u32 s40, s38, 221184
buffer_load_ushort v80, v7, s[12:15], s40 offen
s_add_u32 s40, s38, 224640
buffer_load_ushort v81, v7, s[12:15], s40 offen
s_add_u32 s40, s38, 228096
buffer_load_ushort v82, v7, s[12:15], s40 offen
s_add_u32 s40, s38, 231552
buffer_load_ushort v83, v7, s[12:15], s40 offen
s_add_u32 s40, s38, 235008
buffer_load_ushort v84, v7, s[12:15], s40 offen
s_add_u32 s40, s38, 238464
buffer_load_ushort v85, v7, s[12:15], s40 offen
s_add_u32 s40, s38, 241920
buffer_load_ushort v86, v7, s[12:15], s40 offen
s_add_u32 s40, s38, 245376
buffer_load_ushort v87, v7, s[12:15], s40 offen
s_add_u32 s40, s38, 331776
buffer_load_ushort v88, v7, s[12:15], s40 offen
s_add_u32 s40, s38, 335232
buffer_load_ushort v89, v7, s[12:15], s40 offen
s_add_u32 s40, s38, 338688
buffer_load_ushort v90, v7, s[12:15], s40 offen
s_add_u32 s40, s38, 342144
buffer_load_ushort v91, v7, s[12:15], s40 offen
s_add_u32 s40, s38, 345600
buffer_load_ushort v92, v7, s[12:15], s40 offen
s_add_u32 s40, s38, 349056
buffer_load_ushort v93, v7, s[12:15], s40 offen
s_add_u32 s40, s38, 352512
buffer_load_ushort v94, v7, s[12:15], s40 offen
s_add_u32 s40, s38, 355968
buffer_load_ushort v95, v7, s[12:15], s40 offen
s_add_u32 s40, s38, 442368
buffer_load_ushort v96, v7, s[12:15], s40 offen
s_add_u32 s40, s38, 445824
buffer_load_ushort v97, v7, s[12:15], s40 offen
s_add_u32 s40, s38, 449280
buffer_load_ushort v98, v7, s[12:15], s40 offen
s_add_u32 s40, s38, 452736
buffer_load_ushort v99, v7, s[12:15], s40 offen
s_add_u32 s40, s38, 456192
buffer_load_ushort v100, v7, s[12:15], s40 offen
s_add_u32 s40, s38, 459648
buffer_load_ushort v101, v7, s[12:15], s40 offen
s_add_u32 s40, s38, 463104
buffer_load_ushort v102, v7, s[12:15], s40 offen
s_add_u32 s40, s38, 466560
buffer_load_ushort v103, v7, s[12:15], s40 offen
s_mul_i32 s44, s36, 788480
s_mul_i32 s45, s34, 71680
s_add_u32 s44, s44, s45
s_lshl_b32 s45, s37, 10
s_add_u32 s44, s44, s45
s_add_u32 s44, s44, 225280
s_mul_i32 s46, s36, 896
s_lshl_b32 s45, s37, 6
s_add_u32 s46, s46, s45
s_add_u32 s46, s46, 6332416
v_mov_b32 v132, 0x3f803f80
v_mov_b32 v133, 0x3f803f80
v_mov_b32 v134, 0x3f803f80
v_mov_b32 v135, 0x3f803f80
s_waitcnt vmcnt(0)
buffer_store_dwordx4 v[16:19], v5, s[8:11], s54 offen
buffer_store_dwordx4 v[20:23], v5, s[8:11], s55 offen
s_cmp_lt_u32 s57, 512
s_cbranch_scc0 prep_xd3
buffer_store_dwordx4 v[24:27], v5, s[8:11], s56 offen
prep_xd3:
v_lshl_or_b32 v32, v65, 16, v64
v_lshl_or_b32 v33, v67, 16, v66
v_lshl_or_b32 v34, v69, 16, v68
v_lshl_or_b32 v35, v71, 16, v70
v_lshl_or_b32 v36, v73, 16, v72
v_lshl_or_b32 v37, v75, 16, v74
v_lshl_or_b32 v38, v77, 16, v76
v_lshl_or_b32 v39, v79, 16, v78
v_lshl_or_b32 v40, v81, 16, v80
v_lshl_or_b32 v41, v83, 16, v82
v_lshl_or_b32 v42, v85, 16, v84
v_lshl_or_b32 v43, v87, 16, v86
v_lshl_or_b32 v44, v89, 16, v88
v_lshl_or_b32 v45, v91, 16, v90
v_lshl_or_b32 v46, v93, 16, v92
v_lshl_or_b32 v47, v95, 16, v94
v_lshl_or_b32 v48, v97, 16, v96
v_lshl_or_b32 v49, v99, 16, v98
v_lshl_or_b32 v50, v101, 16, v100
v_lshl_or_b32 v51, v103, 16, v102
s_add_u32 s40, s44, 0
buffer_store_dwordx4 v[32:35], v5, s[8:11], s40 offen
v_mfma_f32_16x16x32_bf16 v[28:31], v[32:35], v[132:135], 0
s_add_u32 s40, s44, 14336
buffer_store_dwordx4 v[36:39], v5, s[8:11], s40 offen
v_mfma_f32_16x16x32_bf16 v[28:31], v[36:39], v[132:135], v[28:31]
s_add_u32 s40, s44, 28672
buffer_store_dwordx4 v[40:43], v5, s[8:11], s40 offen
v_mfma_f32_16x16x32_bf16 v[28:31], v[40:43], v[132:135], v[28:31]
s_add_u32 s40, s44, 43008
buffer_store_dwordx4 v[44:47], v5, s[8:11], s40 offen
v_mfma_f32_16x16x32_bf16 v[28:31], v[44:47], v[132:135], v[28:31]
s_add_u32 s40, s44, 57344
buffer_store_dwordx4 v[48:51], v5, s[8:11], s40 offen
v_mfma_f32_16x16x32_bf16 v[28:31], v[48:51], v[132:135], v[28:31]
v_lshlrev_b32 v6, 4, v4
s_lshl_b32 s41, s34, 6
v_add_u32 v6, s41, v6
v_cmp_eq_u32 vcc, 0, v3
s_nop 2
s_and_saveexec_b64 s[42:43], vcc
ds_write_b128 v6, v[28:31]
s_mov_b64 exec, s[42:43]
s_waitcnt lgkmcnt(0)
s_barrier
v_lshlrev_b32 v6, 2, v0
v_cmp_gt_u32 vcc, 16, v0
s_nop 2
s_and_saveexec_b64 s[42:43], vcc
s_cbranch_execz prep_kernel_exit
ds_read_b32 v7, v6
ds_read_b32 v8, v6 offset:64
ds_read_b32 v9, v6 offset:128
ds_read_b32 v10, v6 offset:192
s_waitcnt lgkmcnt(0)
v_add_f32 v7, v7, v8
v_add_f32 v9, v9, v10
v_add_f32 v7, v7, v9
buffer_store_dword v7, v6, s[8:11], s46 offen
s_waitcnt vmcnt(0)
s_endpgm
prep_plain:
s_sub_u32 s35, s2, 151
s_lshl_b32 s35, s35, 2
s_add_u32 s35, s35, s34
s_cmp_lt_u32 s35, 120
s_cbranch_scc1 prep_wo
s_sub_u32 s35, s35, 120
s_cmp_ge_u32 s35, 280
s_cbranch_scc1 prep_bias
s_mov_b32 s12, s32
s_mov_b32 s13, s33
s_mov_b32 s14, 2211840
s_mov_b32 s15, 0x20000
s_mov_b32 s50, 512000
s_mov_b32 s51, 6
s_mov_b32 s52, 2
s_branch prep_pl2
prep_wo:
s_mov_b32 s12, s28
s_mov_b32 s13, s29
s_mov_b32 s14, 819200
s_mov_b32 s15, 0x20000
s_mov_b32 s50, 122880
s_mov_b32 s51, 2
s_mov_b32 s52, 0
prep_pl2:
s_mul_i32 s36, s35, 1639
s_lshr_b32 s36, s36, 16
s_mul_i32 s37, s36, 40
s_sub_u32 s37, s35, s37
s_mul_i32 s38, s37, 52429
s_lshr_b32 s38, s38, 18
s_mul_i32 s39, s38, 5
s_sub_u32 s39, s37, s39
v_mul_u32_u24 v7, 10240, v4
s_lshl_b32 s45, s37, 5
v_lshl_add_u32 v7, v3, 1, v7
v_add_u32 v7, s45, v7
s_mul_i32 s44, s38, 788480
s_add_u32 s44, s44, s50
s_mul_i32 s45, s36, 40960
s_add_u32 s44, s44, s45
s_lshl_b32 s45, s39, 10
s_add_u32 s44, s44, s45
s_mul_i32 s38, s36, 327680
s_add_u32 s40, s38, 0
buffer_load_ushort v64, v7, s[12:15], s40 offen
s_add_u32 s40, s38, 1280
buffer_load_ushort v65, v7, s[12:15], s40 offen
s_add_u32 s40, s38, 2560
buffer_load_ushort v66, v7, s[12:15], s40 offen
s_add_u32 s40, s38, 3840
buffer_load_ushort v67, v7, s[12:15], s40 offen
s_add_u32 s40, s38, 5120
buffer_load_ushort v68, v7, s[12:15], s40 offen
s_add_u32 s40, s38, 6400
buffer_load_ushort v69, v7, s[12:15], s40 offen
s_add_u32 s40, s38, 7680
buffer_load_ushort v70, v7, s[12:15], s40 offen
s_add_u32 s40, s38, 8960
buffer_load_ushort v71, v7, s[12:15], s40 offen
s_add_u32 s40, s38, 40960
buffer_load_ushort v72, v7, s[12:15], s40 offen
s_add_u32 s40, s38, 42240
buffer_load_ushort v73, v7, s[12:15], s40 offen
s_add_u32 s40, s38, 43520
buffer_load_ushort v74, v7, s[12:15], s40 offen
s_add_u32 s40, s38, 44800
buffer_load_ushort v75, v7, s[12:15], s40 offen
s_add_u32 s40, s38, 46080
buffer_load_ushort v76, v7, s[12:15], s40 offen
s_add_u32 s40, s38, 47360
buffer_load_ushort v77, v7, s[12:15], s40 offen
s_add_u32 s40, s38, 48640
buffer_load_ushort v78, v7, s[12:15], s40 offen
s_add_u32 s40, s38, 49920
buffer_load_ushort v79, v7, s[12:15], s40 offen
s_add_u32 s40, s38, 81920
buffer_load_ushort v80, v7, s[12:15], s40 offen
s_add_u32 s40, s38, 83200
buffer_load_ushort v81, v7, s[12:15], s40 offen
s_add_u32 s40, s38, 84480
buffer_load_ushort v82, v7, s[12:15], s40 offen
s_add_u32 s40, s38, 85760
buffer_load_ushort v83, v7, s[12:15], s40 offen
s_add_u32 s40, s38, 87040
buffer_load_ushort v84, v7, s[12:15], s40 offen
s_add_u32 s40, s38, 88320
buffer_load_ushort v85, v7, s[12:15], s40 offen
s_add_u32 s40, s38, 89600
buffer_load_ushort v86, v7, s[12:15], s40 offen
s_add_u32 s40, s38, 90880
buffer_load_ushort v87, v7, s[12:15], s40 offen
s_add_u32 s40, s38, 122880
buffer_load_ushort v88, v7, s[12:15], s40 offen
s_add_u32 s40, s38, 124160
buffer_load_ushort v89, v7, s[12:15], s40 offen
s_add_u32 s40, s38, 125440
buffer_load_ushort v90, v7, s[12:15], s40 offen
s_add_u32 s40, s38, 126720
buffer_load_ushort v91, v7, s[12:15], s40 offen
s_add_u32 s40, s38, 128000
buffer_load_ushort v92, v7, s[12:15], s40 offen
s_add_u32 s40, s38, 129280
buffer_load_ushort v93, v7, s[12:15], s40 offen
s_add_u32 s40, s38, 130560
buffer_load_ushort v94, v7, s[12:15], s40 offen
s_add_u32 s40, s38, 131840
buffer_load_ushort v95, v7, s[12:15], s40 offen
s_add_u32 s40, s38, 163840
buffer_load_ushort v96, v7, s[12:15], s40 offen
s_add_u32 s40, s38, 165120
buffer_load_ushort v97, v7, s[12:15], s40 offen
s_add_u32 s40, s38, 166400
buffer_load_ushort v98, v7, s[12:15], s40 offen
s_add_u32 s40, s38, 167680
buffer_load_ushort v99, v7, s[12:15], s40 offen
s_add_u32 s40, s38, 168960
buffer_load_ushort v100, v7, s[12:15], s40 offen
s_add_u32 s40, s38, 170240
buffer_load_ushort v101, v7, s[12:15], s40 offen
s_add_u32 s40, s38, 171520
buffer_load_ushort v102, v7, s[12:15], s40 offen
s_add_u32 s40, s38, 172800
buffer_load_ushort v103, v7, s[12:15], s40 offen
s_add_u32 s40, s38, 204800
buffer_load_ushort v104, v7, s[12:15], s40 offen
s_add_u32 s40, s38, 206080
buffer_load_ushort v105, v7, s[12:15], s40 offen
s_add_u32 s40, s38, 207360
buffer_load_ushort v106, v7, s[12:15], s40 offen
s_add_u32 s40, s38, 208640
buffer_load_ushort v107, v7, s[12:15], s40 offen
s_add_u32 s40, s38, 209920
buffer_load_ushort v108, v7, s[12:15], s40 offen
s_add_u32 s40, s38, 211200
buffer_load_ushort v109, v7, s[12:15], s40 offen
s_add_u32 s40, s38, 212480
buffer_load_ushort v110, v7, s[12:15], s40 offen
s_add_u32 s40, s38, 213760
buffer_load_ushort v111, v7, s[12:15], s40 offen
s_add_u32 s40, s38, 245760
buffer_load_ushort v112, v7, s[12:15], s40 offen
s_add_u32 s40, s38, 247040
buffer_load_ushort v113, v7, s[12:15], s40 offen
s_add_u32 s40, s38, 248320
buffer_load_ushort v114, v7, s[12:15], s40 offen
s_add_u32 s40, s38, 249600
buffer_load_ushort v115, v7, s[12:15], s40 offen
s_add_u32 s40, s38, 250880
buffer_load_ushort v116, v7, s[12:15], s40 offen
s_add_u32 s40, s38, 252160
buffer_load_ushort v117, v7, s[12:15], s40 offen
s_add_u32 s40, s38, 253440
buffer_load_ushort v118, v7, s[12:15], s40 offen
s_add_u32 s40, s38, 254720
buffer_load_ushort v119, v7, s[12:15], s40 offen
s_add_u32 s40, s38, 286720
buffer_load_ushort v120, v7, s[12:15], s40 offen
s_add_u32 s40, s38, 288000
buffer_load_ushort v121, v7, s[12:15], s40 offen
s_add_u32 s40, s38, 289280
buffer_load_ushort v122, v7, s[12:15], s40 offen
s_add_u32 s40, s38, 290560
buffer_load_ushort v123, v7, s[12:15], s40 offen
s_add_u32 s40, s38, 291840
buffer_load_ushort v124, v7, s[12:15], s40 offen
s_add_u32 s40, s38, 293120
buffer_load_ushort v125, v7, s[12:15], s40 offen
s_add_u32 s40, s38, 294400
buffer_load_ushort v126, v7, s[12:15], s40 offen
s_add_u32 s40, s38, 295680
buffer_load_ushort v127, v7, s[12:15], s40 offen
s_waitcnt vmcnt(0)
buffer_store_dwordx4 v[16:19], v5, s[8:11], s54 offen
buffer_store_dwordx4 v[20:23], v5, s[8:11], s55 offen
s_cmp_lt_u32 s57, 512
s_cbranch_scc0 prep_xd4
buffer_store_dwordx4 v[24:27], v5, s[8:11], s56 offen
prep_xd4:
v_lshl_or_b32 v32, v65, 16, v64
v_lshl_or_b32 v33, v67, 16, v66
v_lshl_or_b32 v34, v69, 16, v68
v_lshl_or_b32 v35, v71, 16, v70
v_lshl_or_b32 v36, v73, 16, v72
v_lshl_or_b32 v37, v75, 16, v74
v_lshl_or_b32 v38, v77, 16, v76
v_lshl_or_b32 v39, v79, 16, v78
v_lshl_or_b32 v40, v81, 16, v80
v_lshl_or_b32 v41, v83, 16, v82
v_lshl_or_b32 v42, v85, 16, v84
v_lshl_or_b32 v43, v87, 16, v86
v_lshl_or_b32 v44, v89, 16, v88
v_lshl_or_b32 v45, v91, 16, v90
v_lshl_or_b32 v46, v93, 16, v92
v_lshl_or_b32 v47, v95, 16, v94
v_lshl_or_b32 v48, v97, 16, v96
v_lshl_or_b32 v49, v99, 16, v98
v_lshl_or_b32 v50, v101, 16, v100
v_lshl_or_b32 v51, v103, 16, v102
v_lshl_or_b32 v52, v105, 16, v104
v_lshl_or_b32 v53, v107, 16, v106
v_lshl_or_b32 v54, v109, 16, v108
v_lshl_or_b32 v55, v111, 16, v110
v_lshl_or_b32 v56, v113, 16, v112
v_lshl_or_b32 v57, v115, 16, v114
v_lshl_or_b32 v58, v117, 16, v116
v_lshl_or_b32 v59, v119, 16, v118
v_lshl_or_b32 v60, v121, 16, v120
v_lshl_or_b32 v61, v123, 16, v122
v_lshl_or_b32 v62, v125, 16, v124
v_lshl_or_b32 v63, v127, 16, v126
s_add_u32 s40, s44, 0
buffer_store_dwordx4 v[32:35], v5, s[8:11], s40 offen
s_add_u32 s40, s44, 5120
buffer_store_dwordx4 v[36:39], v5, s[8:11], s40 offen
s_add_u32 s40, s44, 10240
buffer_store_dwordx4 v[40:43], v5, s[8:11], s40 offen
s_add_u32 s40, s44, 15360
buffer_store_dwordx4 v[44:47], v5, s[8:11], s40 offen
s_cmp_eq_u32 s36, s51
s_cbranch_scc0 prep_st4
s_cmp_gt_u32 s52, 0
s_cbranch_scc0 prep_done
prep_st4:
s_add_u32 s40, s44, 20480
buffer_store_dwordx4 v[48:51], v5, s[8:11], s40 offen
s_cmp_eq_u32 s36, s51
s_cbranch_scc0 prep_st5
s_cmp_gt_u32 s52, 1
s_cbranch_scc0 prep_done
prep_st5:
s_add_u32 s40, s44, 25600
buffer_store_dwordx4 v[52:55], v5, s[8:11], s40 offen
s_cmp_eq_u32 s36, s51
s_cbranch_scc0 prep_st6
s_cmp_gt_u32 s52, 2
s_cbranch_scc0 prep_done
prep_st6:
s_add_u32 s40, s44, 30720
buffer_store_dwordx4 v[56:59], v5, s[8:11], s40 offen
s_cmp_eq_u32 s36, s51
s_cbranch_scc0 prep_st7
s_cmp_gt_u32 s52, 3
s_cbranch_scc0 prep_done
prep_st7:
s_add_u32 s40, s44, 35840
buffer_store_dwordx4 v[60:63], v5, s[8:11], s40 offen
prep_done:
s_waitcnt vmcnt(0)
s_endpgm
prep_bias:
s_waitcnt vmcnt(0)
buffer_store_dwordx4 v[16:19], v5, s[8:11], s54 offen
buffer_store_dwordx4 v[20:23], v5, s[8:11], s55 offen
s_cmp_lt_u32 s57, 512
s_cbranch_scc0 prep_xd5
buffer_store_dwordx4 v[24:27], v5, s[8:11], s56 offen
prep_xd5:
v_mov_b32 v8, 0
v_mov_b32 v9, 0
v_mov_b32 v10, 0
v_mov_b32 v11, 0
v_lshlrev_b32 v6, 4, v0
s_mov_b32 s40, 6340608
buffer_store_dwordx4 v[8:11], v6, s[8:11], s40 offen
s_mov_b32 s40, 6344704
buffer_store_dwordx4 v[8:11], v6, s[8:11], s40 offen
s_mov_b32 s40, 6348800
buffer_store_dwordx4 v[8:11], v6, s[8:11], s40 offen
s_mov_b32 s40, 6352896
buffer_store_dwordx4 v[8:11], v6, s[8:11], s40 offen
s_mov_b32 s40, 6356992
buffer_store_dwordx4 v[8:11], v6, s[8:11], s40 offen
s_mov_b32 s40, 6361088
buffer_store_dwordx4 v[8:11], v6, s[8:11], s40 offen
s_mov_b32 s40, 6365184
buffer_store_dwordx4 v[8:11], v6, s[8:11], s40 offen
s_mov_b32 s40, 6369280
buffer_store_dwordx4 v[8:11], v6, s[8:11], s40 offen
s_mov_b32 s40, 6373376
buffer_store_dwordx4 v[8:11], v6, s[8:11], s40 offen
s_mov_b32 s40, 6377472
buffer_store_dwordx4 v[8:11], v6, s[8:11], s40 offen
s_mov_b32 s40, 6381568
buffer_store_dwordx4 v[8:11], v6, s[8:11], s40 offen
s_mov_b32 s40, 6385664
buffer_store_dwordx4 v[8:11], v6, s[8:11], s40 offen
s_mov_b32 s40, 6389760
buffer_store_dwordx4 v[8:11], v6, s[8:11], s40 offen
s_mov_b32 s40, 6393856
buffer_store_dwordx4 v[8:11], v6, s[8:11], s40 offen
s_mov_b32 s40, 6397952
buffer_store_dwordx4 v[8:11], v6, s[8:11], s40 offen
s_mov_b32 s40, 6402048
buffer_store_dwordx4 v[8:11], v6, s[8:11], s40 offen
s_mov_b32 s40, 6406144
buffer_store_dwordx4 v[8:11], v6, s[8:11], s40 offen
s_mov_b32 s40, 6410240
buffer_store_dwordx4 v[8:11], v6, s[8:11], s40 offen
s_mov_b32 s40, 6414336
buffer_store_dwordx4 v[8:11], v6, s[8:11], s40 offen
s_mov_b32 s40, 6418432
buffer_store_dwordx4 v[8:11], v6, s[8:11], s40 offen
s_mov_b32 s40, 6422528
buffer_store_dwordx4 v[8:11], v6, s[8:11], s40 offen
s_cmp_eq_u32 s35, 280
s_cbranch_scc0 prep_done2
v_mov_b32 v7, 0
v_cmp_eq_u32 vcc, 38, v1
s_nop 1
v_cndmask_b32 v7, v7, 1.0, vcc
v_cmp_eq_u32 vcc, 42, v1
s_nop 1
v_cndmask_b32 v7, v7, 1.0, vcc
v_cmp_eq_u32 vcc, 44, v1
s_nop 1
v_cndmask_b32 v7, v7, 1.0, vcc
v_cmp_eq_u32 vcc, 45, v1
s_nop 1
v_cndmask_b32 v7, v7, 1.0, vcc
v_lshlrev_b32 v6, 2, v1
v_cmp_gt_u32 vcc, 48, v1
s_nop 2
s_and_saveexec_b64 s[42:43], vcc
s_mov_b32 s40, 6328320
buffer_store_dword v7, v6, s[8:11], s40 offen
prep_done2:
s_waitcnt vmcnt(0)
s_endpgm
prep_kernel_exit:
s_endpgm
.globl main_kernel
.p2align 8
.type main_kernel,@function
main_kernel:
s_cmp_ge_u32 s2, 256
s_cbranch_scc1 main_kernel_exit
s_load_dwordx2 s[4:5], s[0:1], 96
s_load_dwordx2 s[6:7], s[0:1], 0
s_load_dwordx2 s[24:25], s[0:1], 56
s_load_dwordx4 s[28:31], s[0:1], 72
v_and_b32 v1, 63, v0
v_lshrrev_b32 v2, 6, v0
s_nop 0
v_readfirstlane_b32 s34, v2
v_and_b32 v3, 15, v1
v_lshrrev_b32 v4, 4, v1
v_lshlrev_b32 v5, 4, v1
s_and_b32 s35, s2, 31
s_lshr_b32 s36, s2, 5
s_mov_b32 s37, 0
s_waitcnt lgkmcnt(0)
s_mov_b32 s26, s28
s_mov_b32 s27, s29
s_mov_b32 s28, s30
s_mov_b32 s29, s31
s_mov_b32 s8, s4
s_mov_b32 s9, s5
s_mov_b32 s10, 268435456
s_mov_b32 s11, 0x20000
s_lshl_b32 s67, s35, 2
s_and_b32 s38, s34, 3
s_add_u32 s67, s67, s38
s_lshl_b32 s66, s67, 4
s_xor_b32 s65, s67, 1
s_mul_i32 s68, s36, 5
s_lshl_b32 s69, s38, 12
s_mul_i32 s60, s36, 788480
s_add_u32 s60, s60, s69
s_add_u32 s60, s60, 0
s_mov_b32 s59, 0
s_getreg_b32 s58, hwreg(HW_REG_XCC_ID, 0, 4)
s_add_u32 s58, s58, 1
s_cmp_eq_u32 s34, 0
s_cbranch_scc0 pro_x
s_lshl_b32 s40, s35, 5
s_lshl_b32 s41, s36, 2
s_add_u32 s40, s40, s41
s_add_u32 s40, s40, 6422528
v_mov_b32 v8, 0
v_mov_b32 v9, s58
s_mov_b64 s[42:43], exec
s_mov_b64 exec, 1
buffer_store_dword v9, v8, s[8:11], s40 offen sc1
s_mov_b64 exec, s[42:43]
pro_x:
s_cmp_ge_u32 s34, 4
s_cbranch_scc0 pro_c
s_add_u32 m0, s69, 0
s_add_u32 s44, s60, 0
buffer_load_dwordx4 v5, s[8:11], s44 offen offset:0 lds
buffer_load_dwordx4 v5, s[8:11], s44 offen offset:1024 lds
buffer_load_dwordx4 v5, s[8:11], s44 offen offset:2048 lds
buffer_load_dwordx4 v5, s[8:11], s44 offen offset:3072 lds
s_add_u32 m0, s69, 16384
s_add_u32 s44, s60, 16384
buffer_load_dwordx4 v5, s[8:11], s44 offen offset:0 lds
buffer_load_dwordx4 v5, s[8:11], s44 offen offset:1024 lds
buffer_load_dwordx4 v5, s[8:11], s44 offen offset:2048 lds
buffer_load_dwordx4 v5, s[8:11], s44 offen offset:3072 lds
s_branch pro_d
pro_c:
v_add_u32 v6, s66, v3
v_mul_u32_u24 v56, 1280, v6
v_lshl_add_u32 v56, v4, 3, v56
s_mul_i32 s40, s36, 160
v_add_u32 v56, s40, v56
s_mov_b32 s12, s6
s_mov_b32 s13, s7
s_mov_b32 s14, 2621440
s_mov_b32 s15, 0x20000
buffer_load_dwordx2 v[246:247], v56, s[12:15], 0 offen offset:0
buffer_load_dwordx2 v[248:249], v56, s[12:15], 0 offen offset:32
buffer_load_dwordx2 v[250:251], v56, s[12:15], 0 offen offset:64
buffer_load_dwordx2 v[252:253], v56, s[12:15], 0 offen offset:96
buffer_load_dwordx2 v[254:255], v56, s[12:15], 0 offen offset:128
pro_d:
layer_top:
s_cmp_ge_u32 s34, 4
s_cbranch_scc1 ld_qkv
s_mul_i32 s45, s36, 384
s_add_u32 s45, s45, 6324224
v_lshlrev_b32 v58, 4, v4
buffer_load_dwordx4 v[8:11], v58, s[8:11], s45 offen offset:0
buffer_load_dwordx4 v[12:15], v58, s[8:11], s45 offen offset:64
buffer_load_dwordx4 v[16:19], v58, s[8:11], s45 offen offset:128
buffer_load_dwordx4 v[20:23], v58, s[8:11], s45 offen offset:192
buffer_load_dwordx4 v[24:27], v58, s[8:11], s45 offen offset:256
buffer_load_dwordx4 v[28:31], v58, s[8:11], s45 offen offset:320
s_min_u32 s46, s36, 2
s_lshl_b32 s46, s46, 6
s_add_u32 s46, s46, 6328320
buffer_load_dwordx4 v[32:35], v58, s[8:11], s46 offen
v_mov_b32 v52, 0x3f803f80
v_mov_b32 v53, 0x3f803f80
v_mov_b32 v54, 0x3f803f80
v_mov_b32 v55, 0x3f803f80
s_and_b32 s45, s34, 1
s_mul_i32 s44, s45, 1024
v_add_u32 v6, s44, v5
v_add_u32 v7, 0x10000, v6
v_add_u32 v59, 114688, v6
s_xor_b32 s45, s45, 1
s_mul_i32 s44, s45, 113664
v_add_u32 v2, s44, v5
s_cmp_eq_u32 s37, 0
s_cbranch_scc1 qkv_l0
s_lshl_b32 s46, s37, 13
s_and_b32 s45, s67, -2
s_lshl_b32 s45, s45, 6
s_add_u32 s46, s46, s45
s_add_u32 s46, s46, 6397952
v_lshlrev_b32 v56, 2, v1
s_mov_b64 s[42:43], exec
s_mov_b64 exec, 0xff00ff
s_mov_b32 s44, 0
poll_1:
buffer_load_dword v57, v56, s[8:11], s46 offen sc1
s_add_u32 s44, s44, 1
s_waitcnt vmcnt(0)
v_cmp_eq_u32 vcc, 0, v57
s_nop 2
s_cmp_eq_u64 vcc, 0
s_cbranch_scc1 polld_2
s_cmp_gt_u32 s44, 200000
s_cbranch_scc1 polld_2
s_sleep 1
s_branch poll_1
polld_2:
s_mov_b64 exec, s[42:43]
qkv_l0:
s_mul_i32 s40, s67, 20480
s_mul_i32 s41, s65, 20480
s_mul_i32 s45, s37, -2621440
s_add_u32 s45, s45, 34222080
s_and_b32 s44, s34, 1
s_lshl_b32 s44, s44, 10
s_add_u32 s45, s45, s44
s_add_u32 s40, s40, s45
s_add_u32 s41, s41, s45
buffer_load_dwordx4 v[64:67], v5, s[8:11], s40 offen offset:0 sc1
buffer_load_dwordx4 v[68:71], v5, s[8:11], s41 offen offset:0 sc1
buffer_load_dwordx4 v[72:75], v5, s[8:11], s40 offen offset:2048 sc1
buffer_load_dwordx4 v[76:79], v5, s[8:11], s41 offen offset:2048 sc1
s_add_u32 s40, s40, 4096
s_add_u32 s41, s41, 4096
buffer_load_dwordx4 v[80:83], v5, s[8:11], s40 offen offset:0 sc1
buffer_load_dwordx4 v[84:87], v5, s[8:11], s41 offen offset:0 sc1
buffer_load_dwordx4 v[88:91], v5, s[8:11], s40 offen offset:2048 sc1
buffer_load_dwordx4 v[92:95], v5, s[8:11], s41 offen offset:2048 sc1
s_add_u32 s40, s40, 4096
s_add_u32 s41, s41, 4096
buffer_load_dwordx4 v[96:99], v5, s[8:11], s40 offen offset:0 sc1
buffer_load_dwordx4 v[100:103], v5, s[8:11], s41 offen offset:0 sc1
buffer_load_dwordx4 v[104:107], v5, s[8:11], s40 offen offset:2048 sc1
buffer_load_dwordx4 v[108:111], v5, s[8:11], s41 offen offset:2048 sc1
s_add_u32 s40, s40, 4096
s_add_u32 s41, s41, 4096
buffer_load_dwordx4 v[112:115], v5, s[8:11], s40 offen offset:0 sc1
buffer_load_dwordx4 v[116:119], v5, s[8:11], s41 offen offset:0 sc1
buffer_load_dwordx4 v[120:123], v5, s[8:11], s40 offen offset:2048 sc1
buffer_load_dwordx4 v[124:127], v5, s[8:11], s41 offen offset:2048 sc1
s_add_u32 s40, s40, 4096
s_add_u32 s41, s41, 4096
buffer_load_dwordx4 v[128:131], v5, s[8:11], s40 offen offset:0 sc1
buffer_load_dwordx4 v[132:135], v5, s[8:11], s41 offen offset:0 sc1
buffer_load_dwordx4 v[136:139], v5, s[8:11], s40 offen offset:2048 sc1
buffer_load_dwordx4 v[140:143], v5, s[8:11], s41 offen offset:2048 sc1
s_barrier
ds_read_b128 v[144:147], v6 offset:0
s_waitcnt vmcnt(18)
s_waitcnt lgkmcnt(0)
v_mfma_f32_16x16x32_bf16 v[204:207], v[144:147], v[64:67], 0
ds_read_b128 v[148:151], v6 offset:2048
v_mfma_f32_16x16x32_bf16 v[224:227], v[144:147], v[68:71], 0
v_mfma_f32_16x16x32_bf16 v[36:39], v[52:55], v[64:67], 0
v_mfma_f32_16x16x32_bf16 v[40:43], v[64:67], v[64:67], 0
v_mfma_f32_16x16x32_bf16 v[44:47], v[52:55], v[68:71], 0
v_mfma_f32_16x16x32_bf16 v[48:51], v[68:71], v[68:71], 0
s_waitcnt vmcnt(16)
s_waitcnt lgkmcnt(0)
v_mfma_f32_16x16x32_bf16 v[204:207], v[148:151], v[72:75], v[204:207]
ds_read_b128 v[144:147], v6 offset:4096
v_mfma_f32_16x16x32_bf16 v[224:227], v[148:151], v[76:79], v[224:227]
v_mfma_f32_16x16x32_bf16 v[36:39], v[52:55], v[72:75], v[36:39]
v_mfma_f32_16x16x32_bf16 v[40:43], v[72:75], v[72:75], v[40:43]
v_mfma_f32_16x16x32_bf16 v[44:47], v[52:55], v[76:79], v[44:47]
v_mfma_f32_16x16x32_bf16 v[48:51], v[76:79], v[76:79], v[48:51]
s_waitcnt vmcnt(14)
s_waitcnt lgkmcnt(0)
v_mfma_f32_16x16x32_bf16 v[204:207], v[144:147], v[80:83], v[204:207]
ds_read_b128 v[148:151], v6 offset:6144
v_mfma_f32_16x16x32_bf16 v[224:227], v[144:147], v[84:87], v[224:227]
v_mfma_f32_16x16x32_bf16 v[36:39], v[52:55], v[80:83], v[36:39]
v_mfma_f32_16x16x32_bf16 v[40:43], v[80:83], v[80:83], v[40:43]
v_mfma_f32_16x16x32_bf16 v[44:47], v[52:55], v[84:87], v[44:47]
v_mfma_f32_16x16x32_bf16 v[48:51], v[84:87], v[84:87], v[48:51]
s_waitcnt vmcnt(12)
s_waitcnt lgkmcnt(0)
v_mfma_f32_16x16x32_bf16 v[204:207], v[148:151], v[88:91], v[204:207]
ds_read_b128 v[144:147], v6 offset:8192
v_mfma_f32_16x16x32_bf16 v[224:227], v[148:151], v[92:95], v[224:227]
v_mfma_f32_16x16x32_bf16 v[36:39], v[52:55], v[88:91], v[36:39]
v_mfma_f32_16x16x32_bf16 v[40:43], v[88:91], v[88:91], v[40:43]
v_mfma_f32_16x16x32_bf16 v[44:47], v[52:55], v[92:95], v[44:47]
v_mfma_f32_16x16x32_bf16 v[48:51], v[92:95], v[92:95], v[48:51]
s_waitcnt vmcnt(10)
s_waitcnt lgkmcnt(0)
v_mfma_f32_16x16x32_bf16 v[204:207], v[144:147], v[96:99], v[204:207]
ds_read_b128 v[148:151], v6 offset:10240
v_mfma_f32_16x16x32_bf16 v[224:227], v[144:147], v[100:103], v[224:227]
v_mfma_f32_16x16x32_bf16 v[36:39], v[52:55], v[96:99], v[36:39]
v_mfma_f32_16x16x32_bf16 v[40:43], v[96:99], v[96:99], v[40:43]
v_mfma_f32_16x16x32_bf16 v[44:47], v[52:55], v[100:103], v[44:47]
v_mfma_f32_16x16x32_bf16 v[48:51], v[100:103], v[100:103], v[48:51]
s_waitcnt vmcnt(8)
s_waitcnt lgkmcnt(0)
v_mfma_f32_16x16x32_bf16 v[204:207], v[148:151], v[104:107], v[204:207]
ds_read_b128 v[144:147], v6 offset:12288
v_mfma_f32_16x16x32_bf16 v[224:227], v[148:151], v[108:111], v[224:227]
v_mfma_f32_16x16x32_bf16 v[36:39], v[52:55], v[104:107], v[36:39]
v_mfma_f32_16x16x32_bf16 v[40:43], v[104:107], v[104:107], v[40:43]
v_mfma_f32_16x16x32_bf16 v[44:47], v[52:55], v[108:111], v[44:47]
v_mfma_f32_16x16x32_bf16 v[48:51], v[108:111], v[108:111], v[48:51]
s_waitcnt vmcnt(6)
s_waitcnt lgkmcnt(0)
v_mfma_f32_16x16x32_bf16 v[204:207], v[144:147], v[112:115], v[204:207]
ds_read_b128 v[148:151], v6 offset:14336
v_mfma_f32_16x16x32_bf16 v[224:227], v[144:147], v[116:119], v[224:227]
v_mfma_f32_16x16x32_bf16 v[36:39], v[52:55], v[112:115], v[36:39]
v_mfma_f32_16x16x32_bf16 v[40:43], v[112:115], v[112:115], v[40:43]
v_mfma_f32_16x16x32_bf16 v[44:47], v[52:55], v[116:119], v[44:47]
v_mfma_f32_16x16x32_bf16 v[48:51], v[116:119], v[116:119], v[48:51]
s_waitcnt vmcnt(4)
s_waitcnt lgkmcnt(0)
v_mfma_f32_16x16x32_bf16 v[204:207], v[148:151], v[120:123], v[204:207]
ds_read_b128 v[144:147], v6 offset:16384
v_mfma_f32_16x16x32_bf16 v[224:227], v[148:151], v[124:127], v[224:227]
v_mfma_f32_16x16x32_bf16 v[36:39], v[52:55], v[120:123], v[36:39]
v_mfma_f32_16x16x32_bf16 v[40:43], v[120:123], v[120:123], v[40:43]
v_mfma_f32_16x16x32_bf16 v[44:47], v[52:55], v[124:127], v[44:47]
v_mfma_f32_16x16x32_bf16 v[48:51], v[124:127], v[124:127], v[48:51]
s_waitcnt vmcnt(2)
s_waitcnt lgkmcnt(0)
v_mfma_f32_16x16x32_bf16 v[204:207], v[144:147], v[128:131], v[204:207]
ds_read_b128 v[148:151], v6 offset:18432
v_mfma_f32_16x16x32_bf16 v[224:227], v[144:147], v[132:135], v[224:227]
v_mfma_f32_16x16x32_bf16 v[36:39], v[52:55], v[128:131], v[36:39]
v_mfma_f32_16x16x32_bf16 v[40:43], v[128:131], v[128:131], v[40:43]
v_mfma_f32_16x16x32_bf16 v[44:47], v[52:55], v[132:135], v[44:47]
v_mfma_f32_16x16x32_bf16 v[48:51], v[132:135], v[132:135], v[48:51]
s_waitcnt vmcnt(0)
s_waitcnt lgkmcnt(0)
v_mfma_f32_16x16x32_bf16 v[204:207], v[148:151], v[136:139], v[204:207]
v_mfma_f32_16x16x32_bf16 v[224:227], v[148:151], v[140:143], v[224:227]
v_mfma_f32_16x16x32_bf16 v[36:39], v[52:55], v[136:139], v[36:39]
v_mfma_f32_16x16x32_bf16 v[40:43], v[136:139], v[136:139], v[40:43]
v_mfma_f32_16x16x32_bf16 v[44:47], v[52:55], v[140:143], v[44:47]
v_mfma_f32_16x16x32_bf16 v[48:51], v[140:143], v[140:143], v[48:51]
s_and_b32 s45, s34, 3
s_lshl_b32 s44, s45, 13
s_add_u32 s44, s44, 114688
v_add_u32 v56, s44, v5
ds_write_b128 v56, v[224:227] offset:0
s_nop 1
ds_write_b128 v56, v[44:47] offset:6144
ds_write_b128 v56, v[48:51] offset:7168
s_xor_b32 s45, s45, 1
s_lshl_b32 s44, s45, 13
s_add_u32 s44, s44, 114688
v_add_u32 v57, s44, v5
s_waitcnt lgkmcnt(0)
s_barrier
ds_read_b128 v[144:147], v57 offset:0
ds_read_b128 v[44:47], v57 offset:6144
ds_read_b128 v[48:51], v57 offset:7168
s_waitcnt lgkmcnt(0)
v_add_f32 v204, v204, v144
v_add_f32 v205, v205, v145
v_add_f32 v206, v206, v146
v_add_f32 v207, v207, v147
v_add_f32 v36, v36, v44
v_add_f32 v37, v37, v45
v_add_f32 v38, v38, v46
v_add_f32 v39, v39, v47
v_add_f32 v40, v40, v48
v_add_f32 v41, v41, v49
v_add_f32 v42, v42, v50
v_add_f32 v43, v43, v51
v_and_b32 v56, 3, v1
v_mov_b32 v57, v40
v_cmp_eq_u32 vcc, 1, v56
s_nop 1
v_cndmask_b32 v57, v57, v41, vcc
v_cmp_eq_u32 vcc, 2, v56
s_nop 1
v_cndmask_b32 v57, v57, v42, vcc
v_cmp_eq_u32 vcc, 3, v56
s_nop 1
v_cndmask_b32 v57, v57, v43, vcc
v_lshrrev_b32 v58, 2, v3
v_lshlrev_b32 v58, 4, v58
v_add_u32 v58, v58, v3
v_lshlrev_b32 v58, 2, v58
ds_bpermute_b32 v57, v58, v57
v_mul_f32 v56, 0x3acccccd, v36
s_waitcnt lgkmcnt(0)
v_mul_f32 v57, 0x3acccccd, v57
v_fma_f32 v57, -v56, v56, v57
v_max_f32 v57, 0, v57
v_add_f32 v58, 0x3727c5ac, v57
v_rsq_f32 v58, v58
s_nop 0
v_mov_b32 v60, v58
v_mul_f32 v61, v56, v58
v_mul_f32 v62, 0x3ea52b5c, v60
v_mul_f32 v63, 0x3ea52b5c, v61
s_cmp_lt_u32 s36, 3
s_cbranch_scc0 qkv_nokv
v_fma_f32 v48, -v61, v28, v32
v_fma_f32 v48, v60, v204, v48
v_fma_f32 v49, -v61, v29, v33
v_fma_f32 v49, v60, v205, v49
v_fma_f32 v50, -v61, v30, v34
v_fma_f32 v50, v60, v206, v50
v_fma_f32 v51, -v61, v31, v35
v_fma_f32 v51, v60, v207, v51
v_cvt_pk_bf16_f32 v52, v48, v49
v_cvt_pk_bf16_f32 v53, v50, v51
s_and_b32 s38, s34, 1
s_and_b32 s41, s34, 3
s_lshl_b32 s41, s41, 10
s_add_u32 s41, s41, 147456
s_lshr_b32 s47, s67, 1
s_lshl_b32 s47, s47, 12
s_mul_i32 s48, s37, 262144
s_add_u32 s47, s47, s48
s_add_u32 s47, s47, 6426624
s_cmp_eq_u32 s36, 0
s_cbranch_scc1 qkv_kvA
s_cmp_eq_u32 s36, 1
s_cbranch_scc1 qkv_kvB
v_lshlrev_b32 v47, 3, v3
v_add_u32 v47, s41, v47
v_add_u32 v54, 128, v47
v_cmp_eq_u32 vcc, 3, v4
s_nop 1
v_cndmask_b32 v47, v47, v54, vcc
v_cmp_eq_u32 vcc, 0, v4
v_cmp_eq_u32 s[48:49], 3, v4
s_nop 2
s_or_b64 vcc, vcc, s[48:49]
s_and_saveexec_b64 s[50:51], vcc
ds_write_b64 v47, v[52:53]
s_andn2_b64 exec, s[50:51], exec
v_lshlrev_b32 v47, 6, v4
v_add_u32 v47, 192, v47
v_bfe_u32 v54, v3, 2, 1
v_mul_u32_u24 v54, 128, v54
v_bfe_u32 v55, v3, 3, 1
v_lshl_add_u32 v54, v55, 3, v54
v_and_b32 v55, 3, v3
v_lshl_add_u32 v54, v55, 1, v54
v_add3_u32 v54, v54, v47, s41
ds_write_b16 v54, v52
ds_write_b16_d16_hi v54, v52 offset:16
ds_write_b16 v54, v53 offset:32
ds_write_b16_d16_hi v54, v53 offset:48
s_mov_b64 exec, s[50:51]
v_and_b32 v47, 7, v1
v_lshlrev_b32 v47, 4, v47
v_bfe_u32 v54, v1, 3, 2
s_lshl_b32 s49, s38, 7
s_add_u32 s49, s49, 1024
s_lshl_b32 s50, s38, 10
s_add_u32 s50, s50, 2304
v_mov_b32 v55, s49
s_add_u32 s51, s49, 256
v_mov_b32 v50, s51
v_cmp_eq_u32 vcc, 1, v54
s_nop 1
v_cndmask_b32 v55, v55, v50, vcc
v_mov_b32 v50, s50
v_cmp_eq_u32 vcc, 2, v54
s_nop 1
v_cndmask_b32 v55, v55, v50, vcc
s_add_u32 s51, s50, 512
v_mov_b32 v50, s51
v_cmp_eq_u32 vcc, 3, v54
s_nop 1
v_cndmask_b32 v55, v55, v50, vcc
v_add_u32 v47, v47, v55
v_bfe_u32 v54, v1, 3, 1
v_lshlrev_b32 v54, 9, v54
v_and_b32 v55, 7, v1
v_lshl_add_u32 v54, v55, 4, v54
s_add_u32 s51, s50, 128
v_add_u32 v54, s51, v54
v_cmp_le_u32 vcc, 32, v1
s_nop 1
v_cndmask_b32 v47, v47, v54, vcc
s_mov_b32 s52, 1
s_branch qkv_kvout
qkv_kvB:
v_lshlrev_b32 v47, 6, v4
v_bfe_u32 v54, v3, 2, 1
v_mul_u32_u24 v54, 256, v54
v_bfe_u32 v55, v3, 3, 1
v_lshl_add_u32 v54, v55, 3, v54
v_and_b32 v55, 3, v3
v_lshl_add_u32 v54, v55, 1, v54
v_add3_u32 v54, v54, v47, s41
ds_write_b16 v54, v52
ds_write_b16_d16_hi v54, v52 offset:16
ds_write_b16 v54, v53 offset:32
ds_write_b16_d16_hi v54, v53 offset:48
v_lshlrev_b32 v47, 4, v3
v_and_b32 v54, 1, v4
v_lshl_add_u32 v47, v54, 9, v47
s_lshl_b32 s49, s38, 10
s_add_u32 s49, s49, 2048
v_add_u32 v47, s49, v47
s_branch qkv_kvout
qkv_kvA:
v_lshrrev_b32 v47, 1, v4
v_lshlrev_b32 v47, 8, v47
v_lshl_add_u32 v47, v3, 4, v47
v_and_b32 v54, 1, v4
v_lshl_add_u32 v47, v54, 3, v47
v_add_u32 v47, s41, v47
ds_write_b64 v47, v[52:53]
s_lshl_b32 s49, s38, 8
v_lshlrev_b32 v47, 4, v3
v_and_b32 v54, 1, v4
v_lshl_add_u32 v47, v54, 9, v47
v_add_u32 v47, s49, v47
qkv_kvout:
v_add_u32 v54, s41, v5
s_waitcnt lgkmcnt(0)
s_mov_b64 s[50:51], exec
s_mov_b64 exec, 0xffffffff
ds_read_b128 v[48:51], v54
s_waitcnt lgkmcnt(0)
buffer_store_dwordx4 v[48:51], v47, s[8:11], s47 offen sc1
s_cmp_eq_u32 s36, 2
s_cbranch_scc0 qkv_nz
s_mov_b32 exec_lo, 0
s_mov_b32 exec_hi, 0xffff
v_mov_b32 v48, 0
v_mov_b32 v49, 0
v_mov_b32 v50, 0
v_mov_b32 v51, 0
buffer_store_dwordx4 v[48:51], v47, s[8:11], s47 offen sc1
qkv_nz:
s_mov_b64 exec, s[50:51]
qkv_nokv:
s_and_b32 s45, s34, 1
s_mul_i32 s44, s45, 5120
v_add_u32 v6, s44, v5
v_add_u32 v7, 0x10000, v6
v_add_u32 v59, 114688, v6
s_xor_b32 s45, s45, 1
s_mul_i32 s44, s45, 109568
v_add_u32 v2, s44, v5
s_barrier
ds_read_b128 v[144:147], v6 offset:20480
ds_read_b128 v[148:151], v6 offset:21504
ds_read_b128 v[152:155], v6 offset:22528
ds_read_b128 v[156:159], v6 offset:23552
ds_read_b128 v[160:163], v6 offset:24576
s_waitcnt lgkmcnt(4)
v_mfma_f32_16x16x32_bf16 v[204:207], v[144:147], v[64:67], 0
ds_read_b128 v[164:167], v6 offset:30720
v_mfma_f32_16x16x32_bf16 v[224:227], v[144:147], v[68:71], 0
s_waitcnt lgkmcnt(4)
v_mfma_f32_16x16x32_bf16 v[208:211], v[148:151], v[64:67], 0
ds_read_b128 v[168:171], v6 offset:31744
v_mfma_f32_16x16x32_bf16 v[228:231], v[148:151], v[68:71], 0
s_waitcnt lgkmcnt(4)
v_mfma_f32_16x16x32_bf16 v[212:215], v[152:155], v[64:67], 0
ds_read_b128 v[172:175], v6 offset:32768
v_mfma_f32_16x16x32_bf16 v[232:235], v[152:155], v[68:71], 0
s_waitcnt lgkmcnt(4)
v_mfma_f32_16x16x32_bf16 v[216:219], v[156:159], v[64:67], 0
ds_read_b128 v[176:179], v6 offset:33792
v_mfma_f32_16x16x32_bf16 v[236:239], v[156:159], v[68:71], 0
s_waitcnt lgkmcnt(4)
v_mfma_f32_16x16x32_bf16 v[220:223], v[160:163], v[64:67], 0
ds_read_b128 v[180:183], v6 offset:34816
v_mfma_f32_16x16x32_bf16 v[240:243], v[160:163], v[68:71], 0
s_barrier
s_waitcnt lgkmcnt(4)
v_mfma_f32_16x16x32_bf16 v[204:207], v[164:167], v[72:75], v[204:207]
ds_read_b128 v[144:147], v6 offset:40960
v_mfma_f32_16x16x32_bf16 v[224:227], v[164:167], v[76:79], v[224:227]
s_waitcnt lgkmcnt(4)
v_mfma_f32_16x16x32_bf16 v[208:211], v[168:171], v[72:75], v[208:211]
ds_read_b128 v[148:151], v6 offset:41984
v_mfma_f32_16x16x32_bf16 v[228:231], v[168:171], v[76:79], v[228:231]
s_waitcnt lgkmcnt(4)
v_mfma_f32_16x16x32_bf16 v[212:215], v[172:175], v[72:75], v[212:215]
ds_read_b128 v[152:155], v6 offset:43008
v_mfma_f32_16x16x32_bf16 v[232:235], v[172:175], v[76:79], v[232:235]
s_waitcnt lgkmcnt(4)
v_mfma_f32_16x16x32_bf16 v[216:219], v[176:179], v[72:75], v[216:219]
ds_read_b128 v[156:159], v6 offset:44032
v_mfma_f32_16x16x32_bf16 v[236:239], v[176:179], v[76:79], v[236:239]
s_waitcnt lgkmcnt(4)
v_mfma_f32_16x16x32_bf16 v[220:223], v[180:183], v[72:75], v[220:223]
ds_read_b128 v[160:163], v6 offset:45056
v_mfma_f32_16x16x32_bf16 v[240:243], v[180:183], v[76:79], v[240:243]
s_waitcnt lgkmcnt(4)
v_mfma_f32_16x16x32_bf16 v[204:207], v[144:147], v[80:83], v[204:207]
ds_read_b128 v[164:167], v6 offset:51200
v_mfma_f32_16x16x32_bf16 v[224:227], v[144:147], v[84:87], v[224:227]
s_waitcnt lgkmcnt(4)
v_mfma_f32_16x16x32_bf16 v[208:211], v[148:151], v[80:83], v[208:211]
ds_read_b128 v[168:171], v6 offset:52224
v_mfma_f32_16x16x32_bf16 v[228:231], v[148:151], v[84:87], v[228:231]
s_waitcnt lgkmcnt(4)
v_mfma_f32_16x16x32_bf16 v[212:215], v[152:155], v[80:83], v[212:215]
ds_read_b128 v[172:175], v6 offset:53248
v_mfma_f32_16x16x32_bf16 v[232:235], v[152:155], v[84:87], v[232:235]
s_waitcnt lgkmcnt(4)
v_mfma_f32_16x16x32_bf16 v[216:219], v[156:159], v[80:83], v[216:219]
ds_read_b128 v[176:179], v6 offset:54272
v_mfma_f32_16x16x32_bf16 v[236:239], v[156:159], v[84:87], v[236:239]
s_waitcnt lgkmcnt(4)
v_mfma_f32_16x16x32_bf16 v[220:223], v[160:163], v[80:83], v[220:223]
ds_read_b128 v[180:183], v6 offset:55296
v_mfma_f32_16x16x32_bf16 v[240:243], v[160:163], v[84:87], v[240:243]
s_waitcnt vmcnt(0)
s_barrier
s_cmp_eq_u32 s34, 0
s_cbranch_scc0 kvpub_3
s_cmp_lt_u32 s36, 3
s_cbranch_scc0 kvpub_3
s_lshl_b32 s46, s37, 13
s_lshr_b32 s45, s35, 3
s_lshl_b32 s45, s45, 11
s_add_u32 s46, s46, s45
s_add_u32 s46, s46, 6340608
v_lshlrev_b32 v56, 8, v1
v_mov_b32 v57, 1
s_mov_b64 s[42:43], exec
s_mov_b64 exec, 0xff
buffer_atomic_add v57, v56, s[8:11], s46 offen
s_mov_b64 exec, s[42:43]
kvpub_3:
s_waitcnt lgkmcnt(4)
v_mfma_f32_16x16x32_bf16 v[204:207], v[164:167], v[88:91], v[204:207]
ds_read_b128 v[144:147], v6 offset:61440
v_mfma_f32_16x16x32_bf16 v[224:227], v[164:167], v[92:95], v[224:227]
s_waitcnt lgkmcnt(4)
v_mfma_f32_16x16x32_bf16 v[208:211], v[168:171], v[88:91], v[208:211]
ds_read_b128 v[148:151], v6 offset:62464
v_mfma_f32_16x16x32_bf16 v[228:231], v[168:171], v[92:95], v[228:231]
s_waitcnt lgkmcnt(4)
v_mfma_f32_16x16x32_bf16 v[212:215], v[172:175], v[88:91], v[212:215]
ds_read_b128 v[152:155], v6 offset:63488
v_mfma_f32_16x16x32_bf16 v[232:235], v[172:175], v[92:95], v[232:235]
s_waitcnt lgkmcnt(4)
v_mfma_f32_16x16x32_bf16 v[216:219], v[176:179], v[88:91], v[216:219]
ds_read_b128 v[156:159], v6 offset:64512
v_mfma_f32_16x16x32_bf16 v[236:239], v[176:179], v[92:95], v[236:239]
s_waitcnt lgkmcnt(4)
v_mfma_f32_16x16x32_bf16 v[220:223], v[180:183], v[88:91], v[220:223]
ds_read_b128 v[160:163], v7 offset:0
v_mfma_f32_16x16x32_bf16 v[240:243], v[180:183], v[92:95], v[240:243]
s_waitcnt lgkmcnt(4)
v_mfma_f32_16x16x32_bf16 v[204:207], v[144:147], v[96:99], v[204:207]
ds_read_b128 v[164:167], v7 offset:6144
v_mfma_f32_16x16x32_bf16 v[224:227], v[144:147], v[100:103], v[224:227]
s_waitcnt lgkmcnt(4)
v_mfma_f32_16x16x32_bf16 v[208:211], v[148:151], v[96:99], v[208:211]
ds_read_b128 v[168:171], v7 offset:7168
v_mfma_f32_16x16x32_bf16 v[228:231], v[148:151], v[100:103], v[228:231]
s_waitcnt lgkmcnt(4)
v_mfma_f32_16x16x32_bf16 v[212:215], v[152:155], v[96:99], v[212:215]
ds_read_b128 v[172:175], v7 offset:8192
v_mfma_f32_16x16x32_bf16 v[232:235], v[152:155], v[100:103], v[232:235]
s_waitcnt lgkmcnt(4)
v_mfma_f32_16x16x32_bf16 v[216:219], v[156:159], v[96:99], v[216:219]
ds_read_b128 v[176:179], v7 offset:9216
v_mfma_f32_16x16x32_bf16 v[236:239], v[156:159], v[100:103], v[236:239]
s_waitcnt lgkmcnt(4)
v_mfma_f32_16x16x32_bf16 v[220:223], v[160:163], v[96:99], v[220:223]
ds_read_b128 v[180:183], v7 offset:10240
v_mfma_f32_16x16x32_bf16 v[240:243], v[160:163], v[100:103], v[240:243]
s_barrier
s_waitcnt lgkmcnt(4)
v_mfma_f32_16x16x32_bf16 v[204:207], v[164:167], v[104:107], v[204:207]
ds_read_b128 v[144:147], v7 offset:16384
v_mfma_f32_16x16x32_bf16 v[224:227], v[164:167], v[108:111], v[224:227]
s_waitcnt lgkmcnt(4)
v_mfma_f32_16x16x32_bf16 v[208:211], v[168:171], v[104:107], v[208:211]
ds_read_b128 v[148:151], v7 offset:17408
v_mfma_f32_16x16x32_bf16 v[228:231], v[168:171], v[108:111], v[228:231]
s_waitcnt lgkmcnt(4)
v_mfma_f32_16x16x32_bf16 v[212:215], v[172:175], v[104:107], v[212:215]
ds_read_b128 v[152:155], v7 offset:18432
v_mfma_f32_16x16x32_bf16 v[232:235], v[172:175], v[108:111], v[232:235]
s_waitcnt lgkmcnt(4)
v_mfma_f32_16x16x32_bf16 v[216:219], v[176:179], v[104:107], v[216:219]
ds_read_b128 v[156:159], v7 offset:19456
v_mfma_f32_16x16x32_bf16 v[236:239], v[176:179], v[108:111], v[236:239]
s_waitcnt lgkmcnt(4)
v_mfma_f32_16x16x32_bf16 v[220:223], v[180:183], v[104:107], v[220:223]
ds_read_b128 v[160:163], v7 offset:20480
v_mfma_f32_16x16x32_bf16 v[240:243], v[180:183], v[108:111], v[240:243]
s_waitcnt lgkmcnt(4)
v_mfma_f32_16x16x32_bf16 v[204:207], v[144:147], v[112:115], v[204:207]
ds_read_b128 v[164:167], v7 offset:26624
v_mfma_f32_16x16x32_bf16 v[224:227], v[144:147], v[116:119], v[224:227]
s_waitcnt lgkmcnt(4)
v_mfma_f32_16x16x32_bf16 v[208:211], v[148:151], v[112:115], v[208:211]
ds_read_b128 v[168:171], v7 offset:27648
v_mfma_f32_16x16x32_bf16 v[228:231], v[148:151], v[116:119], v[228:231]
s_waitcnt lgkmcnt(4)
v_mfma_f32_16x16x32_bf16 v[212:215], v[152:155], v[112:115], v[212:215]
ds_read_b128 v[172:175], v7 offset:28672
v_mfma_f32_16x16x32_bf16 v[232:235], v[152:155], v[116:119], v[232:235]
s_waitcnt lgkmcnt(4)
v_mfma_f32_16x16x32_bf16 v[216:219], v[156:159], v[112:115], v[216:219]
ds_read_b128 v[176:179], v7 offset:29696
v_mfma_f32_16x16x32_bf16 v[236:239], v[156:159], v[116:119], v[236:239]
s_waitcnt lgkmcnt(4)
v_mfma_f32_16x16x32_bf16 v[220:223], v[160:163], v[112:115], v[220:223]
ds_read_b128 v[180:183], v7 offset:30720
v_mfma_f32_16x16x32_bf16 v[240:243], v[160:163], v[116:119], v[240:243]
s_barrier
s_waitcnt lgkmcnt(4)
v_mfma_f32_16x16x32_bf16 v[204:207], v[164:167], v[120:123], v[204:207]
ds_read_b128 v[144:147], v7 offset:36864
v_mfma_f32_16x16x32_bf16 v[224:227], v[164:167], v[124:127], v[224:227]
s_waitcnt lgkmcnt(4)
v_mfma_f32_16x16x32_bf16 v[208:211], v[168:171], v[120:123], v[208:211]
ds_read_b128 v[148:151], v7 offset:37888
v_mfma_f32_16x16x32_bf16 v[228:231], v[168:171], v[124:127], v[228:231]
s_waitcnt lgkmcnt(4)
v_mfma_f32_16x16x32_bf16 v[212:215], v[172:175], v[120:123], v[212:215]
ds_read_b128 v[152:155], v7 offset:38912
v_mfma_f32_16x16x32_bf16 v[232:235], v[172:175], v[124:127], v[232:235]
s_waitcnt lgkmcnt(4)
v_mfma_f32_16x16x32_bf16 v[216:219], v[176:179], v[120:123], v[216:219]
ds_read_b128 v[156:159], v7 offset:39936
v_mfma_f32_16x16x32_bf16 v[236:239], v[176:179], v[124:127], v[236:239]
s_waitcnt lgkmcnt(4)
v_mfma_f32_16x16x32_bf16 v[220:223], v[180:183], v[120:123], v[220:223]
ds_read_b128 v[160:163], v7 offset:40960
v_mfma_f32_16x16x32_bf16 v[240:243], v[180:183], v[124:127], v[240:243]
s_waitcnt lgkmcnt(4)
v_mfma_f32_16x16x32_bf16 v[204:207], v[144:147], v[128:131], v[204:207]
ds_read_b128 v[164:167], v2 offset:3072
v_mfma_f32_16x16x32_bf16 v[224:227], v[144:147], v[132:135], v[224:227]
s_waitcnt lgkmcnt(4)
v_mfma_f32_16x16x32_bf16 v[208:211], v[148:151], v[128:131], v[208:211]
ds_read_b128 v[168:171], v2 offset:4096
v_mfma_f32_16x16x32_bf16 v[228:231], v[148:151], v[132:135], v[228:231]
s_waitcnt lgkmcnt(4)
v_mfma_f32_16x16x32_bf16 v[212:215], v[152:155], v[128:131], v[212:215]
ds_read_b128 v[172:175], v6 offset:0
v_mfma_f32_16x16x32_bf16 v[232:235], v[152:155], v[132:135], v[232:235]
s_waitcnt lgkmcnt(4)
v_mfma_f32_16x16x32_bf16 v[216:219], v[156:159], v[128:131], v[216:219]
ds_read_b128 v[176:179], v6 offset:1024
v_mfma_f32_16x16x32_bf16 v[236:239], v[156:159], v[132:135], v[236:239]
s_waitcnt lgkmcnt(4)
v_mfma_f32_16x16x32_bf16 v[220:223], v[160:163], v[128:131], v[220:223]
ds_read_b128 v[180:183], v6 offset:2048
v_mfma_f32_16x16x32_bf16 v[240:243], v[160:163], v[132:135], v[240:243]
s_waitcnt lgkmcnt(4)
v_mfma_f32_16x16x32_bf16 v[204:207], v[164:167], v[136:139], v[204:207]
v_mfma_f32_16x16x32_bf16 v[224:227], v[164:167], v[140:143], v[224:227]
s_waitcnt lgkmcnt(3)
v_mfma_f32_16x16x32_bf16 v[208:211], v[168:171], v[136:139], v[208:211]
v_mfma_f32_16x16x32_bf16 v[228:231], v[168:171], v[140:143], v[228:231]
s_waitcnt lgkmcnt(2)
v_mfma_f32_16x16x32_bf16 v[212:215], v[172:175], v[136:139], v[212:215]
v_mfma_f32_16x16x32_bf16 v[232:235], v[172:175], v[140:143], v[232:235]
s_waitcnt lgkmcnt(1)
v_mfma_f32_16x16x32_bf16 v[216:219], v[176:179], v[136:139], v[216:219]
v_mfma_f32_16x16x32_bf16 v[236:239], v[176:179], v[140:143], v[236:239]
s_waitcnt lgkmcnt(0)
v_mfma_f32_16x16x32_bf16 v[220:223], v[180:183], v[136:139], v[220:223]
v_mfma_f32_16x16x32_bf16 v[240:243], v[180:183], v[140:143], v[240:243]
v_lshlrev_b32 v170, 3, v1
s_and_b32 s38, s34, 3
s_lshl_b32 s46, s37, 13
s_lshl_b32 s45, s38, 11
s_add_u32 s46, s46, s45
s_and_b32 s45, s2, 7
s_lshl_b32 s45, s45, 8
s_add_u32 s46, s46, s45
s_add_u32 s46, s46, 6340608
v_mov_b32 v175, 0
buffer_load_dword v176, v175, s[8:11], s46 offen sc1
s_and_b32 s45, s34, 3
s_lshl_b32 s44, s45, 13
s_add_u32 s44, s44, 114688
v_add_u32 v194, s44, v5
ds_write_b128 v194, v[224:227] offset:0
ds_write_b128 v194, v[228:231] offset:1024
ds_write_b128 v194, v[232:235] offset:2048
ds_write_b128 v194, v[236:239] offset:3072
ds_write_b128 v194, v[240:243] offset:4096
s_xor_b32 s45, s45, 1
s_lshl_b32 s44, s45, 13
s_add_u32 s44, s44, 114688
v_add_u32 v195, s44, v5
s_waitcnt lgkmcnt(0)
s_barrier
ds_read_b128 v[144:147], v195 offset:0
ds_read_b128 v[148:151], v195 offset:1024
ds_read_b128 v[152:155], v195 offset:2048
ds_read_b128 v[156:159], v195 offset:3072
ds_read_b128 v[160:163], v195 offset:4096
s_waitcnt lgkmcnt(0)
v_add_f32 v204, v204, v144
v_add_f32 v205, v205, v145
v_add_f32 v206, v206, v146
v_add_f32 v207, v207, v147
v_add_f32 v208, v208, v148
v_add_f32 v209, v209, v149
v_add_f32 v210, v210, v150
v_add_f32 v211, v211, v151
v_add_f32 v212, v212, v152
v_add_f32 v213, v213, v153
v_add_f32 v214, v214, v154
v_add_f32 v215, v215, v155
v_add_f32 v216, v216, v156
v_add_f32 v217, v217, v157
v_add_f32 v218, v218, v158
v_add_f32 v219, v219, v159
v_add_f32 v220, v220, v160
v_add_f32 v221, v221, v161
v_add_f32 v222, v222, v162
v_add_f32 v223, v223, v163
s_mov_b32 s48, 0
v_mov_b32 v175, 0
kvp_4:
s_add_u32 s48, s48, 1
s_waitcnt vmcnt(0)
v_readfirstlane_b32 s45, v176
s_nop 2
s_cmp_ge_u32 s45, 24
s_cbranch_scc1 kvpd_5
s_cmp_gt_u32 s48, 200000
s_cbranch_scc1 kvpd_5
s_sleep 1
buffer_load_dword v176, v175, s[8:11], s46 offen sc1
s_branch kvp_4
kvpd_5:
s_and_b32 s38, s34, 3
s_mul_i32 s47, s37, 262144
s_add_u32 s47, s47, 6426624
s_lshl_b32 s48, s38, 16
s_add_u32 s47, s47, s48
buffer_load_dwordx4 v[32:35], v5, s[8:11], s47 offen sc1
buffer_load_dwordx2 v[36:37], v170, s[8:11], s47 offen offset:1024 sc1
buffer_load_dwordx4 v[40:43], v5, s[8:11], s47 offen offset:2048 sc1
buffer_load_dwordx4 v[44:47], v5, s[8:11], s47 offen offset:3072 sc1
s_add_u32 s47, s47, 4096
buffer_load_dwordx4 v[48:51], v5, s[8:11], s47 offen sc1
buffer_load_dwordx2 v[52:53], v170, s[8:11], s47 offen offset:1024 sc1
s_and_b32 s38, s34, 3
s_lshl_b32 s38, s38, 4
v_add_u32 v184, s38, v3
v_mul_u32_u24 v184, 192, v184
v_add_u32 v184, 151552, v184
v_mul_f32 v188, v63, v8
v_fma_f32 v188, v62, v204, -v188
v_mul_f32 v189, v63, v9
v_fma_f32 v189, v62, v205, -v189
v_mul_f32 v190, v63, v10
v_fma_f32 v190, v62, v206, -v190
v_mul_f32 v191, v63, v11
v_fma_f32 v191, v62, v207, -v191
v_cvt_pk_bf16_f32 v192, v188, v189
v_cvt_pk_bf16_f32 v193, v190, v191
v_add_u32 v185, 0, v4
v_mul_u32_u24 v186, 52, v185
v_lshrrev_b32 v186, 8, v186
v_add_u32 v185, v185, v186
v_lshl_add_u32 v185, v185, 3, v184
ds_write_b64 v185, v[192:193]
v_mul_f32 v188, v63, v12
v_fma_f32 v188, v62, v208, -v188
v_mul_f32 v189, v63, v13
v_fma_f32 v189, v62, v209, -v189
v_mul_f32 v190, v63, v14
v_fma_f32 v190, v62, v210, -v190
v_mul_f32 v191, v63, v15
v_fma_f32 v191, v62, v211, -v191
v_cvt_pk_bf16_f32 v192, v188, v189
v_cvt_pk_bf16_f32 v193, v190, v191
v_add_u32 v185, 4, v4
v_mul_u32_u24 v186, 52, v185
v_lshrrev_b32 v186, 8, v186
v_add_u32 v185, v185, v186
v_lshl_add_u32 v185, v185, 3, v184
ds_write_b64 v185, v[192:193]
v_mul_f32 v188, v63, v16
v_fma_f32 v188, v62, v212, -v188
v_mul_f32 v189, v63, v17
v_fma_f32 v189, v62, v213, -v189
v_mul_f32 v190, v63, v18
v_fma_f32 v190, v62, v214, -v190
v_mul_f32 v191, v63, v19
v_fma_f32 v191, v62, v215, -v191
v_cvt_pk_bf16_f32 v192, v188, v189
v_cvt_pk_bf16_f32 v193, v190, v191
v_add_u32 v185, 8, v4
v_mul_u32_u24 v186, 52, v185
v_lshrrev_b32 v186, 8, v186
v_add_u32 v185, v185, v186
v_lshl_add_u32 v185, v185, 3, v184
ds_write_b64 v185, v[192:193]
v_mul_f32 v188, v63, v20
v_fma_f32 v188, v62, v216, -v188
v_mul_f32 v189, v63, v21
v_fma_f32 v189, v62, v217, -v189
v_mul_f32 v190, v63, v22
v_fma_f32 v190, v62, v218, -v190
v_mul_f32 v191, v63, v23
v_fma_f32 v191, v62, v219, -v191
v_cvt_pk_bf16_f32 v192, v188, v189
v_cvt_pk_bf16_f32 v193, v190, v191
v_add_u32 v185, 12, v4
v_mul_u32_u24 v186, 52, v185
v_lshrrev_b32 v186, 8, v186
v_add_u32 v185, v185, v186
v_lshl_add_u32 v185, v185, 3, v184
ds_write_b64 v185, v[192:193]
v_mul_f32 v188, v63, v24
v_fma_f32 v188, v62, v220, -v188
v_mul_f32 v189, v63, v25
v_fma_f32 v189, v62, v221, -v189
v_mul_f32 v190, v63, v26
v_fma_f32 v190, v62, v222, -v190
v_mul_f32 v191, v63, v27
v_fma_f32 v191, v62, v223, -v191
v_cvt_pk_bf16_f32 v192, v188, v189
v_cvt_pk_bf16_f32 v193, v190, v191
v_add_u32 v185, 16, v4
v_mul_u32_u24 v186, 52, v185
v_lshrrev_b32 v186, 8, v186
v_add_u32 v185, v185, v186
v_lshl_add_u32 v185, v185, 3, v184
ds_write_b64 v185, v[192:193]
s_waitcnt lgkmcnt(0)
s_barrier
att_top:
v_and_b32 v6, 31, v1
v_lshrrev_b32 v7, 5, v1
v_lshlrev_b32 v170, 3, v1
s_cmp_ge_u32 s34, 4
s_cbranch_scc0 att_q
s_and_b32 s38, s34, 3
s_lshl_b32 s46, s37, 13
s_lshl_b32 s45, s38, 11
s_add_u32 s46, s46, s45
s_and_b32 s45, s2, 7
s_lshl_b32 s45, s45, 8
s_add_u32 s46, s46, s45
s_add_u32 s46, s46, 6340608
v_mov_b32 v175, 0
buffer_load_dword v176, v175, s[8:11], s46 offen sc1
att_q:
s_and_b32 s38, s34, 3
s_lshr_b32 s39, s34, 2
v_lshrrev_b32 v171, 2, v6
v_mul_u32_u24 v171, 192, v171
v_and_b32 v172, 3, v6
v_mul_u32_u24 v172, 48, v172
v_add_u32 v171, v171, v172
s_add_u32 s40, s38, 0
s_and_b32 s40, s40, 3
s_lshl_b32 s41, s39, 2
s_add_u32 s40, s40, s41
s_mul_i32 s40, s40, 1536
s_add_u32 s40, s40, 151552
v_add_u32 v173, s40, v171
v_lshl_add_u32 v174, v7, 4, v173
ds_read_b128 v[8:11], v174
ds_read_b64 v[12:13], v173 offset:32
s_add_u32 s40, s38, 1
s_and_b32 s40, s40, 3
s_lshl_b32 s41, s39, 2
s_add_u32 s40, s40, s41
s_mul_i32 s40, s40, 1536
s_add_u32 s40, s40, 151552
v_add_u32 v173, s40, v171
v_lshl_add_u32 v174, v7, 4, v173
ds_read_b128 v[14:17], v174
ds_read_b64 v[18:19], v173 offset:32
s_add_u32 s40, s38, 2
s_and_b32 s40, s40, 3
s_lshl_b32 s41, s39, 2
s_add_u32 s40, s40, s41
s_mul_i32 s40, s40, 1536
s_add_u32 s40, s40, 151552
v_add_u32 v173, s40, v171
v_lshl_add_u32 v174, v7, 4, v173
ds_read_b128 v[20:23], v174
ds_read_b64 v[24:25], v173 offset:32
s_add_u32 s40, s38, 3
s_and_b32 s40, s40, 3
s_lshl_b32 s41, s39, 2
s_add_u32 s40, s40, s41
s_mul_i32 s40, s40, 1536
s_add_u32 s40, s40, 151552
v_add_u32 v173, s40, v171
v_lshl_add_u32 v174, v7, 4, v173
ds_read_b128 v[26:29], v174
ds_read_b64 v[30:31], v173 offset:32
s_mov_b32 s57, 0
s_waitcnt lgkmcnt(0)
v_cmp_eq_u32 vcc, 1, v7
s_nop 1
v_cndmask_b32 v12, v12, 0, vcc
v_cndmask_b32 v13, v13, 0, vcc
v_cndmask_b32 v18, v18, 0, vcc
v_cndmask_b32 v19, v19, 0, vcc
v_cndmask_b32 v24, v24, 0, vcc
v_cndmask_b32 v25, v25, 0, vcc
v_cndmask_b32 v30, v30, 0, vcc
v_cndmask_b32 v31, v31, 0, vcc
s_cmp_ge_u32 s34, 4
s_cbranch_scc0 att_go
s_mov_b32 s48, 0
v_mov_b32 v175, 0
kvp_6:
s_add_u32 s48, s48, 1
s_waitcnt vmcnt(0)
v_readfirstlane_b32 s45, v176
s_nop 2
s_cmp_ge_u32 s45, 24
s_cbranch_scc1 kvpd_7
s_cmp_gt_u32 s48, 200000
s_cbranch_scc1 kvpd_7
s_sleep 1
buffer_load_dword v176, v175, s[8:11], s46 offen sc1
s_branch kvp_6
kvpd_7:
att_main:
s_and_b32 s38, s34, 3
s_mul_i32 s47, s37, 262144
s_add_u32 s47, s47, 6426624
s_lshl_b32 s48, s38, 16
s_add_u32 s47, s47, s48
buffer_load_dwordx4 v[32:35], v5, s[8:11], s47 offen sc1
buffer_load_dwordx2 v[36:37], v170, s[8:11], s47 offen offset:1024 sc1
buffer_load_dwordx4 v[40:43], v5, s[8:11], s47 offen offset:2048 sc1
buffer_load_dwordx4 v[44:47], v5, s[8:11], s47 offen offset:3072 sc1
s_add_u32 s47, s47, 4096
buffer_load_dwordx4 v[48:51], v5, s[8:11], s47 offen sc1
buffer_load_dwordx2 v[52:53], v170, s[8:11], s47 offen offset:1024 sc1
att_go:
v_mov_b32 v104, 0
v_mov_b32 v105, 0
v_mov_b32 v106, 0
v_mov_b32 v107, 0
v_mov_b32 v108, 0
v_mov_b32 v109, 0
v_mov_b32 v110, 0
v_mov_b32 v111, 0
v_mov_b32 v112, 0
v_mov_b32 v113, 0
v_mov_b32 v114, 0
v_mov_b32 v115, 0
v_mov_b32 v116, 0
v_mov_b32 v117, 0
v_mov_b32 v118, 0
v_mov_b32 v119, 0
v_mov_b32 v120, 0
v_mov_b32 v121, 0
v_mov_b32 v122, 0
v_mov_b32 v123, 0
v_mov_b32 v124, 0
v_mov_b32 v125, 0
v_mov_b32 v126, 0
v_mov_b32 v127, 0
v_mov_b32 v128, 0
v_mov_b32 v129, 0
v_mov_b32 v130, 0
v_mov_b32 v131, 0
v_mov_b32 v132, 0
v_mov_b32 v133, 0
v_mov_b32 v134, 0
v_mov_b32 v135, 0
v_mov_b32 v136, 0
v_mov_b32 v137, 0
v_mov_b32 v138, 0
v_mov_b32 v139, 0
v_mov_b32 v140, 0
v_mov_b32 v141, 0
v_mov_b32 v142, 0
v_mov_b32 v143, 0
v_mov_b32 v144, 0
v_mov_b32 v145, 0
v_mov_b32 v146, 0
v_mov_b32 v147, 0
v_mov_b32 v148, 0
v_mov_b32 v149, 0
v_mov_b32 v150, 0
v_mov_b32 v151, 0
v_mov_b32 v152, 0
v_mov_b32 v153, 0
v_mov_b32 v154, 0
v_mov_b32 v155, 0
v_mov_b32 v156, 0
v_mov_b32 v157, 0
v_mov_b32 v158, 0
v_mov_b32 v159, 0
v_mov_b32 v160, 0
v_mov_b32 v161, 0
v_mov_b32 v162, 0
v_mov_b32 v163, 0
v_mov_b32 v164, 0
v_mov_b32 v165, 0
v_mov_b32 v166, 0
v_mov_b32 v167, 0
v_mov_b32 v68, 0
v_mov_b32 v60, 0
v_mov_b32 v100, 0
v_mov_b32 v69, 0
v_mov_b32 v61, 0
v_mov_b32 v101, 0
v_mov_b32 v70, 0
v_mov_b32 v62, 0
v_mov_b32 v102, 0
v_mov_b32 v71, 0
v_mov_b32 v63, 0
v_mov_b32 v103, 0
s_waitcnt vmcnt(4)
v_mfma_f32_32x32x16_bf16 v[72:87], v[32:35], v[8:11], 0
v_mfma_f32_32x32x8_bf16 v[72:87], v[36:37], v[12:13], v[72:87]
s_mov_b32 s49, 0
s_cmp_eq_u32 s37, 0
s_cbranch_scc0 att_nochk
s_lshl_b32 s46, s35, 5
s_add_u32 s46, s46, 6422528
v_lshlrev_b32 v175, 2, v1
s_mov_b64 s[42:43], exec
s_mov_b64 exec, 0xff
s_mov_b32 s44, 0
poll_8:
buffer_load_dword v176, v175, s[8:11], s46 offen sc1
s_add_u32 s44, s44, 1
s_waitcnt vmcnt(0)
v_cmp_eq_u32 vcc, 0, v176
s_nop 2
s_cmp_eq_u64 vcc, 0
s_cbranch_scc1 polld_9
s_cmp_gt_u32 s44, 200000
s_cbranch_scc1 polld_9
s_sleep 1
s_branch poll_8
polld_9:
s_mov_b64 exec, s[42:43]
s_mov_b64 s[42:43], exec
s_mov_b64 exec, 0xff
v_cmp_ne_u32 vcc, s58, v176
s_nop 2
s_cmp_eq_u64 vcc, 0
s_cselect_b32 s59, 1, 0
s_mov_b64 exec, s[42:43]
att_nochk:
s_mul_i32 s88, s36, 788480
s_lshr_b32 s45, s35, 3
s_mul_i32 s45, s45, 98304
s_add_u32 s88, s88, s45
s_add_u32 s88, s88, 229376
s_lshl_b32 s45, s34, 12
s_add_u32 s88, s88, s45
s_add_u32 s89, s88, 32768
s_add_u32 s90, s88, 65536
s_and_b32 s40, s34, 3
s_lshl_b32 s41, s35, 2
s_add_u32 s40, s40, s41
s_cmp_ge_u32 s34, 4
s_cbranch_scc1 dst_h
s_mul_i32 s41, s40, 20480
s_mul_i32 s45, s36, 2560
s_add_u32 s41, s41, s45
s_mul_i32 s91, s37, 2621440
s_add_u32 s91, s91, 6959104
s_add_u32 s91, s91, s41
s_mul_i32 s92, s37, 2621440
s_add_u32 s92, s92, 12201984
s_add_u32 s92, s92, s41
s_add_u32 s93, s41, 31600640
s_mov_b32 s61, 3
s_mov_b32 s62, 39
s_branch dst_d
dst_h:
s_lshr_b32 s44, s36, 1
s_mul_i32 s44, s44, 27
s_and_b32 s45, s36, 1
s_mul_i32 s45, s45, 14
s_add_u32 s44, s44, s45
s_lshl_b32 s44, s44, 9
s_mul_i32 s41, s40, 55296
s_add_u32 s44, s44, s41
s_mul_i32 s45, s37, 7077888
s_add_u32 s44, s44, s45
s_add_u32 s91, s44, 17444864
s_add_u32 s92, s91, 4096
s_mov_b32 s93, s92
s_mov_b32 s61, 4
s_bitcmp1_b32 s36, 0
s_cselect_b32 s62, 39, 47
dst_d:
s_mov_b32 s94, s93
s_mov_b32 s95, s93
s_nop 7
att_loop:
v_exp_f32 v72, v72
v_exp_f32 v73, v73
v_cvt_pk_bf16_f32 v70, v100, v101
v_cvt_pk_bf16_f32 v71, v102, v103
v_exp_f32 v74, v74
v_exp_f32 v75, v75
v_mfma_f32_32x32x16_bf16 v[88:103], v[32:35], v[14:17], 0
v_exp_f32 v76, v76
v_exp_f32 v77, v77
v_cvt_pk_bf16_f32 v64, v72, v73
v_cvt_pk_bf16_f32 v65, v74, v75
v_exp_f32 v78, v78
v_exp_f32 v79, v79
v_mfma_f32_32x32x8_bf16 v[88:103], v[36:37], v[18:19], v[88:103]
v_exp_f32 v80, v80
v_exp_f32 v81, v81
v_cvt_pk_bf16_f32 v66, v76, v77
v_cvt_pk_bf16_f32 v67, v78, v79
v_exp_f32 v82, v82
v_exp_f32 v83, v83
v_mfma_f32_32x32x16_bf16 v[152:167], v[60:63], v[68:71], v[152:167]
buffer_load_dwordx4 v[56:59], v5, s[8:11], s47 offen offset:2048 sc1
v_exp_f32 v84, v84
v_exp_f32 v85, v85
v_cvt_pk_bf16_f32 v68, v80, v81
v_cvt_pk_bf16_f32 v69, v82, v83
v_exp_f32 v86, v86
v_exp_f32 v87, v87
s_waitcnt vmcnt(3)
v_mfma_f32_32x32x16_bf16 v[104:119], v[40:43], v[64:67], v[104:119]
v_exp_f32 v88, v88
v_exp_f32 v89, v89
v_cvt_pk_bf16_f32 v70, v84, v85
v_cvt_pk_bf16_f32 v71, v86, v87
v_exp_f32 v90, v90
v_exp_f32 v91, v91
v_mfma_f32_32x32x16_bf16 v[72:87], v[32:35], v[20:23], 0
v_exp_f32 v92, v92
v_exp_f32 v93, v93
v_cvt_pk_bf16_f32 v64, v88, v89
v_cvt_pk_bf16_f32 v65, v90, v91
v_exp_f32 v94, v94
v_exp_f32 v95, v95
v_mfma_f32_32x32x8_bf16 v[72:87], v[36:37], v[24:25], v[72:87]
v_exp_f32 v96, v96
v_exp_f32 v97, v97
v_cvt_pk_bf16_f32 v66, v92, v93
v_cvt_pk_bf16_f32 v67, v94, v95
v_exp_f32 v98, v98
v_exp_f32 v99, v99
v_mfma_f32_32x32x16_bf16 v[104:119], v[44:47], v[68:71], v[104:119]
buffer_load_dwordx4 v[60:63], v5, s[8:11], s47 offen offset:3072 sc1
v_exp_f32 v100, v100
v_exp_f32 v101, v101
v_cvt_pk_bf16_f32 v68, v96, v97
v_cvt_pk_bf16_f32 v69, v98, v99
v_exp_f32 v102, v102
v_exp_f32 v103, v103
v_mfma_f32_32x32x16_bf16 v[120:135], v[40:43], v[64:67], v[120:135]
v_exp_f32 v72, v72
v_exp_f32 v73, v73
v_cvt_pk_bf16_f32 v70, v100, v101
v_cvt_pk_bf16_f32 v71, v102, v103
v_exp_f32 v74, v74
v_exp_f32 v75, v75
v_mfma_f32_32x32x16_bf16 v[88:103], v[32:35], v[26:29], 0
v_exp_f32 v76, v76
v_exp_f32 v77, v77
v_cvt_pk_bf16_f32 v64, v72, v73
v_cvt_pk_bf16_f32 v65, v74, v75
v_exp_f32 v78, v78
v_exp_f32 v79, v79
v_mfma_f32_32x32x8_bf16 v[88:103], v[36:37], v[30:31], v[88:103]
v_exp_f32 v80, v80
v_exp_f32 v81, v81
v_cvt_pk_bf16_f32 v66, v76, v77
v_cvt_pk_bf16_f32 v67, v78, v79
v_exp_f32 v82, v82
v_exp_f32 v83, v83
v_mfma_f32_32x32x16_bf16 v[120:135], v[44:47], v[68:71], v[120:135]
v_exp_f32 v84, v84
v_exp_f32 v85, v85
v_cvt_pk_bf16_f32 v68, v80, v81
v_cvt_pk_bf16_f32 v69, v82, v83
v_exp_f32 v86, v86
v_exp_f32 v87, v87
v_mfma_f32_32x32x16_bf16 v[136:151], v[40:43], v[64:67], v[136:151]
v_exp_f32 v88, v88
v_exp_f32 v89, v89
v_cvt_pk_bf16_f32 v70, v84, v85
v_cvt_pk_bf16_f32 v71, v86, v87
v_exp_f32 v90, v90
v_exp_f32 v91, v91
s_waitcnt vmcnt(2)
v_mfma_f32_32x32x16_bf16 v[72:87], v[48:51], v[8:11], 0
v_exp_f32 v92, v92
v_exp_f32 v93, v93
v_cvt_pk_bf16_f32 v64, v88, v89
v_cvt_pk_bf16_f32 v65, v90, v91
v_exp_f32 v94, v94
v_exp_f32 v95, v95
v_mfma_f32_32x32x8_bf16 v[72:87], v[52:53], v[12:13], v[72:87]
s_add_u32 s47, s47, 4096
buffer_load_dwordx4 v[32:35], v5, s[8:11], s47 offen sc1
buffer_load_dwordx2 v[36:37], v170, s[8:11], s47 offen offset:1024 sc1
s_mov_b32 m0, s49
s_cmp_lt_u32 s49, s61
s_cselect_b32 s63, 63, s62
s_movrels_b32 s50, s88
v_min_u32 v177, s63, v1
v_lshlrev_b32 v177, 6, v177
buffer_load_dword v178, v177, s[8:11], s50 offen
v_exp_f32 v96, v96
v_exp_f32 v97, v97
v_cvt_pk_bf16_f32 v66, v92, v93
v_cvt_pk_bf16_f32 v67, v94, v95
v_exp_f32 v98, v98
v_exp_f32 v99, v99
v_mfma_f32_32x32x16_bf16 v[136:151], v[44:47], v[68:71], v[136:151]
v_exp_f32 v100, v100
v_exp_f32 v101, v101
v_cvt_pk_bf16_f32 v68, v96, v97
v_cvt_pk_bf16_f32 v69, v98, v99
v_exp_f32 v102, v102
v_exp_f32 v103, v103
v_mfma_f32_32x32x16_bf16 v[152:167], v[40:43], v[64:67], v[152:167]
v_exp_f32 v72, v72
v_exp_f32 v73, v73
v_cvt_pk_bf16_f32 v70, v100, v101
v_cvt_pk_bf16_f32 v71, v102, v103
v_exp_f32 v74, v74
v_exp_f32 v75, v75
v_mfma_f32_32x32x16_bf16 v[88:103], v[48:51], v[14:17], 0
v_exp_f32 v76, v76
v_exp_f32 v77, v77
v_cvt_pk_bf16_f32 v64, v72, v73
v_cvt_pk_bf16_f32 v65, v74, v75
v_exp_f32 v78, v78
v_exp_f32 v79, v79
v_mfma_f32_32x32x8_bf16 v[88:103], v[52:53], v[18:19], v[88:103]
v_exp_f32 v80, v80
v_exp_f32 v81, v81
v_cvt_pk_bf16_f32 v66, v76, v77
v_cvt_pk_bf16_f32 v67, v78, v79
v_exp_f32 v82, v82
v_exp_f32 v83, v83
v_mfma_f32_32x32x16_bf16 v[152:167], v[44:47], v[68:71], v[152:167]
buffer_load_dwordx4 v[40:43], v5, s[8:11], s47 offen offset:2048 sc1
v_exp_f32 v84, v84
v_exp_f32 v85, v85
v_cvt_pk_bf16_f32 v68, v80, v81
v_cvt_pk_bf16_f32 v69, v82, v83
v_exp_f32 v86, v86
v_exp_f32 v87, v87
s_waitcnt vmcnt(4)
v_mfma_f32_32x32x16_bf16 v[104:119], v[56:59], v[64:67], v[104:119]
v_exp_f32 v88, v88
v_exp_f32 v89, v89
v_cvt_pk_bf16_f32 v70, v84, v85
v_cvt_pk_bf16_f32 v71, v86, v87
v_exp_f32 v90, v90
v_exp_f32 v91, v91
v_mfma_f32_32x32x16_bf16 v[72:87], v[48:51], v[20:23], 0
v_exp_f32 v92, v92
v_exp_f32 v93, v93
v_cvt_pk_bf16_f32 v64, v88, v89
v_cvt_pk_bf16_f32 v65, v90, v91
v_exp_f32 v94, v94
v_exp_f32 v95, v95
v_mfma_f32_32x32x8_bf16 v[72:87], v[52:53], v[24:25], v[72:87]
v_exp_f32 v96, v96
v_exp_f32 v97, v97
v_cvt_pk_bf16_f32 v66, v92, v93
v_cvt_pk_bf16_f32 v67, v94, v95
v_exp_f32 v98, v98
v_exp_f32 v99, v99
v_mfma_f32_32x32x16_bf16 v[104:119], v[60:63], v[68:71], v[104:119]
buffer_load_dwordx4 v[44:47], v5, s[8:11], s47 offen offset:3072 sc1
v_exp_f32 v100, v100
v_exp_f32 v101, v101
v_cvt_pk_bf16_f32 v68, v96, v97
v_cvt_pk_bf16_f32 v69, v98, v99
v_exp_f32 v102, v102
v_exp_f32 v103, v103
v_mfma_f32_32x32x16_bf16 v[120:135], v[56:59], v[64:67], v[120:135]
v_exp_f32 v72, v72
v_exp_f32 v73, v73
v_cvt_pk_bf16_f32 v70, v100, v101
v_cvt_pk_bf16_f32 v71, v102, v103
v_exp_f32 v74, v74
v_exp_f32 v75, v75
v_mfma_f32_32x32x16_bf16 v[88:103], v[48:51], v[26:29], 0
v_exp_f32 v76, v76
v_exp_f32 v77, v77
v_cvt_pk_bf16_f32 v64, v72, v73
v_cvt_pk_bf16_f32 v65, v74, v75
v_exp_f32 v78, v78
v_exp_f32 v79, v79
v_mfma_f32_32x32x8_bf16 v[88:103], v[52:53], v[30:31], v[88:103]
v_exp_f32 v80, v80
v_exp_f32 v81, v81
v_cvt_pk_bf16_f32 v66, v76, v77
v_cvt_pk_bf16_f32 v67, v78, v79
v_exp_f32 v82, v82
v_exp_f32 v83, v83
v_mfma_f32_32x32x16_bf16 v[120:135], v[60:63], v[68:71], v[120:135]
v_exp_f32 v84, v84
v_exp_f32 v85, v85
v_cvt_pk_bf16_f32 v68, v80, v81
v_cvt_pk_bf16_f32 v69, v82, v83
v_exp_f32 v86, v86
v_exp_f32 v87, v87
v_mfma_f32_32x32x16_bf16 v[136:151], v[56:59], v[64:67], v[136:151]
v_exp_f32 v88, v88
v_exp_f32 v89, v89
v_cvt_pk_bf16_f32 v70, v84, v85
v_cvt_pk_bf16_f32 v71, v86, v87
v_exp_f32 v90, v90
v_exp_f32 v91, v91
s_waitcnt vmcnt(3)
v_mfma_f32_32x32x16_bf16 v[72:87], v[32:35], v[8:11], 0
v_exp_f32 v92, v92
v_exp_f32 v93, v93
v_cvt_pk_bf16_f32 v64, v88, v89
v_cvt_pk_bf16_f32 v65, v90, v91
v_exp_f32 v94, v94
v_exp_f32 v95, v95
v_mfma_f32_32x32x8_bf16 v[72:87], v[36:37], v[12:13], v[72:87]
s_add_u32 s47, s47, 4096
buffer_load_dwordx4 v[48:51], v5, s[8:11], s47 offen sc1
buffer_load_dwordx2 v[52:53], v170, s[8:11], s47 offen offset:1024 sc1
v_exp_f32 v96, v96
v_exp_f32 v97, v97
v_cvt_pk_bf16_f32 v66, v92, v93
v_cvt_pk_bf16_f32 v67, v94, v95
v_exp_f32 v98, v98
v_exp_f32 v99, v99
v_mfma_f32_32x32x16_bf16 v[136:151], v[60:63], v[68:71], v[136:151]
v_exp_f32 v100, v100
v_exp_f32 v101, v101
v_cvt_pk_bf16_f32 v68, v96, v97
v_cvt_pk_bf16_f32 v69, v98, v99
v_exp_f32 v102, v102
v_exp_f32 v103, v103
v_mfma_f32_32x32x16_bf16 v[152:167], v[56:59], v[64:67], v[152:167]
s_add_u32 s49, s49, 1
s_cmp_lt_u32 s49, 8
s_cbranch_scc1 att_loop
s_setprio 0
v_cvt_pk_bf16_f32 v70, v100, v101
v_cvt_pk_bf16_f32 v71, v102, v103
s_nop 1
v_mfma_f32_32x32x16_bf16 v[152:167], v[60:63], v[68:71], v[152:167]
s_mul_i32 s40, s34, 4608
s_add_u32 s40, s40, 114688
v_add_u32 v171, s40, v5
v_add_u32 v172, s40, v170
v_add_u32 v172, 1024, v172
v_cvt_pk_bf16_f32 v72, v120, v121
v_cvt_pk_bf16_f32 v73, v122, v123
v_cvt_pk_bf16_f32 v74, v124, v125
v_cvt_pk_bf16_f32 v75, v126, v127
v_cvt_pk_bf16_f32 v76, v128, v129
v_mov_b32 v77, v130
ds_write_b128 v171, v[72:75] offset:0
ds_write_b64 v172, v[76:77] offset:0
v_cvt_pk_bf16_f32 v80, v136, v137
v_cvt_pk_bf16_f32 v81, v138, v139
v_cvt_pk_bf16_f32 v82, v140, v141
v_cvt_pk_bf16_f32 v83, v142, v143
v_cvt_pk_bf16_f32 v84, v144, v145
v_mov_b32 v85, v146
ds_write_b128 v171, v[80:83] offset:1536
ds_write_b64 v172, v[84:85] offset:1536
v_cvt_pk_bf16_f32 v88, v152, v153
v_cvt_pk_bf16_f32 v89, v154, v155
v_cvt_pk_bf16_f32 v90, v156, v157
v_cvt_pk_bf16_f32 v91, v158, v159
v_cvt_pk_bf16_f32 v92, v160, v161
v_mov_b32 v93, v162
ds_write_b128 v171, v[88:91] offset:3072
ds_write_b64 v172, v[92:93] offset:3072
v_mov_b32 v175, 163776
v_mov_b32 v176, 0
ds_write_b32 v175, v176
s_waitcnt lgkmcnt(0)
s_barrier
s_sub_u32 s41, s38, 1
s_and_b32 s41, s41, 3
s_lshl_b32 s45, s39, 2
s_add_u32 s41, s41, s45
s_mul_i32 s41, s41, 4608
s_add_u32 s41, s41, 114688
v_add_u32 v171, s41, v5
v_add_u32 v172, s41, v170
ds_read_b128 v[72:75], v171
ds_read_b64 v[76:77], v172 offset:1024
s_sub_u32 s41, s38, 2
s_and_b32 s41, s41, 3
s_lshl_b32 s45, s39, 2
s_add_u32 s41, s41, s45
s_mul_i32 s41, s41, 4608
s_add_u32 s41, s41, 116224
v_add_u32 v171, s41, v5
v_add_u32 v172, s41, v170
ds_read_b128 v[80:83], v171
ds_read_b64 v[84:85], v172 offset:1024
s_sub_u32 s41, s38, 3
s_and_b32 s41, s41, 3
s_lshl_b32 s45, s39, 2
s_add_u32 s41, s41, s45
s_mul_i32 s41, s41, 4608
s_add_u32 s41, s41, 117760
v_add_u32 v171, s41, v5
v_add_u32 v172, s41, v170
ds_read_b128 v[88:91], v171
ds_read_b64 v[92:93], v172 offset:1024
s_waitcnt vmcnt(0) lgkmcnt(0)
v_lshlrev_b32 v173, 16, v72
v_and_b32 v174, 0xffff0000, v72
v_add_f32 v104, v104, v173
v_add_f32 v105, v105, v174
v_lshlrev_b32 v173, 16, v73
v_and_b32 v174, 0xffff0000, v73
v_add_f32 v106, v106, v173
v_add_f32 v107, v107, v174
v_lshlrev_b32 v173, 16, v74
v_and_b32 v174, 0xffff0000, v74
v_add_f32 v108, v108, v173
v_add_f32 v109, v109, v174
v_lshlrev_b32 v173, 16, v75
v_and_b32 v174, 0xffff0000, v75
v_add_f32 v110, v110, v173
v_add_f32 v111, v111, v174
v_lshlrev_b32 v173, 16, v76
v_and_b32 v174, 0xffff0000, v76
v_add_f32 v112, v112, v173
v_add_f32 v113, v113, v174
v_add_f32 v114, v114, v77
v_lshlrev_b32 v173, 16, v80
v_and_b32 v174, 0xffff0000, v80
v_add_f32 v104, v104, v173
v_add_f32 v105, v105, v174
v_lshlrev_b32 v173, 16, v81
v_and_b32 v174, 0xffff0000, v81
v_add_f32 v106, v106, v173
v_add_f32 v107, v107, v174
v_lshlrev_b32 v173, 16, v82
v_and_b32 v174, 0xffff0000, v82
v_add_f32 v108, v108, v173
v_add_f32 v109, v109, v174
v_lshlrev_b32 v173, 16, v83
v_and_b32 v174, 0xffff0000, v83
v_add_f32 v110, v110, v173
v_add_f32 v111, v111, v174
v_lshlrev_b32 v173, 16, v84
v_and_b32 v174, 0xffff0000, v84
v_add_f32 v112, v112, v173
v_add_f32 v113, v113, v174
v_add_f32 v114, v114, v85
v_lshlrev_b32 v173, 16, v88
v_and_b32 v174, 0xffff0000, v88
v_add_f32 v104, v104, v173
v_add_f32 v105, v105, v174
v_lshlrev_b32 v173, 16, v89
v_and_b32 v174, 0xffff0000, v89
v_add_f32 v106, v106, v173
v_add_f32 v107, v107, v174
v_lshlrev_b32 v173, 16, v90
v_and_b32 v174, 0xffff0000, v90
v_add_f32 v108, v108, v173
v_add_f32 v109, v109, v174
v_lshlrev_b32 v173, 16, v91
v_and_b32 v174, 0xffff0000, v91
v_add_f32 v110, v110, v173
v_add_f32 v111, v111, v174
v_lshlrev_b32 v173, 16, v92
v_and_b32 v174, 0xffff0000, v92
v_add_f32 v112, v112, v173
v_add_f32 v113, v113, v174
v_add_f32 v114, v114, v93
s_cmp_eq_u32 s57, 1
s_cbranch_scc1 att_fin
v_mov_b32 v173, 0
v_fma_f32 v173, v104, 0, v173
v_fma_f32 v173, v105, 0, v173
v_fma_f32 v173, v106, 0, v173
v_fma_f32 v173, v107, 0, v173
v_fma_f32 v173, v108, 0, v173
v_fma_f32 v173, v109, 0, v173
v_fma_f32 v173, v110, 0, v173
v_fma_f32 v173, v111, 0, v173
v_fma_f32 v173, v112, 0, v173
v_fma_f32 v173, v113, 0, v173
v_cmp_lt_f32 vcc, 0x21800000, v114
v_mov_b32 v174, 0x5d800000
v_cmp_gt_f32 s[40:41], v174, v114
s_nop 2
s_and_b64 vcc, vcc, s[40:41]
v_cmp_eq_f32 s[40:41], 0, v173
s_nop 2
s_and_b64 vcc, vcc, s[40:41]
s_cmp_eq_u64 vcc, -1
s_cbranch_scc1 att_okw
v_mov_b32 v175, 163776
v_mov_b32 v176, 1
ds_write_b32 v175, v176
s_waitcnt lgkmcnt(0)
att_okw:
s_barrier
v_mov_b32 v175, 163776
ds_read_b32 v176, v175
s_waitcnt lgkmcnt(0)
v_readfirstlane_b32 s40, v176
s_nop 2
s_cmp_eq_u32 s40, 0
s_cbranch_scc0 att_fallback
att_fin:
v_rcp_f32 v173, v114
s_nop 0
v_mul_f32 v104, v104, v173
v_mul_f32 v105, v105, v173
v_mul_f32 v106, v106, v173
v_mul_f32 v107, v107, v173
v_mul_f32 v108, v108, v173
v_mul_f32 v109, v109, v173
v_mul_f32 v110, v110, v173
v_mul_f32 v111, v111, v173
v_mul_f32 v112, v112, v173
v_mul_f32 v113, v113, v173
v_cvt_pk_bf16_f32 v64, v104, v105
v_cvt_pk_bf16_f32 v65, v106, v107
v_cvt_pk_bf16_f32 v66, v108, v109
v_cvt_pk_bf16_f32 v67, v110, v111
v_cvt_pk_bf16_f32 v68, v112, v113
s_mul_i32 s40, s34, 1280
s_add_u32 s40, s40, 151552
v_lshrrev_b32 v171, 2, v6
v_mul_u32_u24 v171, 160, v171
v_and_b32 v172, 3, v6
v_mul_u32_u24 v172, 40, v172
v_mul_u32_u24 v173, 20, v7
v_add3_u32 v171, v171, v172, v173
v_add_u32 v171, s40, v171
ds_write_b32 v171, v64 offset:0
ds_write_b32 v171, v65 offset:4
ds_write_b32 v171, v66 offset:8
ds_write_b32 v171, v67 offset:12
ds_write_b32 v171, v68 offset:16
v_and_b32 v172, 7, v1
v_lshrrev_b32 v173, 3, v1
v_mul_u32_u24 v174, 160, v172
v_lshl_add_u32 v174, v173, 4, v174
v_add_u32 v174, s40, v174
s_waitcnt lgkmcnt(0)
ds_read_b128 v[72:75], v174
ds_read_b128 v[76:79], v174 offset:128
s_and_b32 s41, s34, 1
s_lshl_b32 s41, s41, 7
v_lshlrev_b32 v172, 4, v172
v_lshl_add_u32 v172, v173, 8, v172
v_add_u32 v172, s41, v172
s_lshl_b32 s41, s35, 2
s_lshr_b32 s45, s34, 1
s_add_u32 s48, s41, s45
s_mul_i32 s41, s48, 20480
s_mul_i32 s45, s36, 2560
s_add_u32 s41, s41, s45
s_mul_i32 s45, s37, 2621440
s_add_u32 s41, s41, s45
s_add_u32 s41, s41, 6959104
s_waitcnt lgkmcnt(0)
s_cmp_eq_u32 s59, 1
s_cbranch_scc1 xs_10
buffer_store_dwordx4 v[72:75], v172, s[8:11], s41 offen sc1
s_mov_b64 s[42:43], exec
s_mov_b64 exec, 0xffff
buffer_store_dwordx4 v[76:79], v172, s[8:11], s41 offen offset:2048 sc1
s_mov_b64 exec, s[42:43]
s_branch xs_11
xs_10:
buffer_store_dwordx4 v[72:75], v172, s[8:11], s41 offen
s_mov_b64 s[42:43], exec
s_mov_b64 exec, 0xffff
buffer_store_dwordx4 v[76:79], v172, s[8:11], s41 offen offset:2048
s_mov_b64 exec, s[42:43]
xs_11:
s_lshl_b32 s46, s37, 13
s_lshl_b32 s45, s48, 6
s_add_u32 s46, s46, s45
s_add_u32 s46, s46, 6356992
s_lshl_b32 s45, s36, 3
s_add_u32 s46, s46, s45
s_and_b32 s45, s34, 1
s_lshl_b32 s45, s45, 2
s_add_u32 s46, s46, s45
s_waitcnt vmcnt(0)
v_mov_b32 v175, 0
v_mov_b32 v176, 1
s_mov_b64 s[42:43], exec
s_mov_b64 exec, 1
s_cmp_eq_u32 s59, 1
s_cbranch_scc1 sf_12
buffer_store_dword v176, v175, s[8:11], s46 offen sc1
s_branch sf_13
sf_12:
buffer_store_dword v176, v175, s[8:11], s46 offen
sf_13:
s_mov_b64 exec, s[42:43]
s_cmp_ge_u32 s34, 4
s_cbranch_scc1 ld_wo
s_and_b32 s45, s34, 1
s_mul_i32 s44, s45, 5120
v_add_u32 v6, s44, v5
v_add_u32 v7, 0x10000, v6
v_add_u32 v59, 114688, v6
s_xor_b32 s45, s45, 1
s_mul_i32 s44, s45, 109568
v_add_u32 v2, s44, v5
s_lshl_b32 s46, s37, 13
s_and_b32 s45, s67, -2
s_lshl_b32 s45, s45, 6
s_add_u32 s46, s46, s45
s_add_u32 s46, s46, 6356992
v_lshlrev_b32 v56, 2, v1
s_mov_b64 s[42:43], exec
s_mov_b64 exec, 0xffffffff
s_mov_b32 s44, 0
poll_14:
buffer_load_dword v57, v56, s[8:11], s46 offen sc1
s_add_u32 s44, s44, 1
s_waitcnt vmcnt(0)
v_cmp_eq_u32 vcc, 0, v57
s_nop 2
s_cmp_eq_u64 vcc, 0
s_cbranch_scc1 polld_15
s_cmp_gt_u32 s44, 200000
s_cbranch_scc1 polld_15
s_sleep 1
s_branch poll_14
polld_15:
s_mov_b64 exec, s[42:43]
s_mul_i32 s40, s67, 20480
s_mul_i32 s41, s65, 20480
s_mul_i32 s45, s37, 2621440
s_add_u32 s45, s45, 6959104
s_and_b32 s44, s34, 1
s_lshl_b32 s44, s44, 10
s_add_u32 s45, s45, s44
s_add_u32 s40, s40, s45
s_add_u32 s41, s41, s45
buffer_load_dwordx4 v[64:67], v5, s[8:11], s40 offen offset:0 sc1
buffer_load_dwordx4 v[68:71], v5, s[8:11], s41 offen offset:0 sc1
buffer_load_dwordx4 v[72:75], v5, s[8:11], s40 offen offset:2048 sc1
buffer_load_dwordx4 v[76:79], v5, s[8:11], s41 offen offset:2048 sc1
s_add_u32 s40, s40, 4096
s_add_u32 s41, s41, 4096
buffer_load_dwordx4 v[80:83], v5, s[8:11], s40 offen offset:0 sc1
buffer_load_dwordx4 v[84:87], v5, s[8:11], s41 offen offset:0 sc1
buffer_load_dwordx4 v[88:91], v5, s[8:11], s40 offen offset:2048 sc1
buffer_load_dwordx4 v[92:95], v5, s[8:11], s41 offen offset:2048 sc1
s_add_u32 s40, s40, 4096
s_add_u32 s41, s41, 4096
buffer_load_dwordx4 v[96:99], v5, s[8:11], s40 offen offset:0 sc1
buffer_load_dwordx4 v[100:103], v5, s[8:11], s41 offen offset:0 sc1
buffer_load_dwordx4 v[104:107], v5, s[8:11], s40 offen offset:2048 sc1
buffer_load_dwordx4 v[108:111], v5, s[8:11], s41 offen offset:2048 sc1
s_add_u32 s40, s40, 4096
s_add_u32 s41, s41, 4096
buffer_load_dwordx4 v[112:115], v5, s[8:11], s40 offen offset:0 sc1
buffer_load_dwordx4 v[116:119], v5, s[8:11], s41 offen offset:0 sc1
buffer_load_dwordx4 v[120:123], v5, s[8:11], s40 offen offset:2048 sc1
buffer_load_dwordx4 v[124:127], v5, s[8:11], s41 offen offset:2048 sc1
s_add_u32 s40, s40, 4096
s_add_u32 s41, s41, 4096
buffer_load_dwordx4 v[128:131], v5, s[8:11], s40 offen offset:0 sc1
buffer_load_dwordx4 v[132:135], v5, s[8:11], s41 offen offset:0 sc1
buffer_load_dwordx4 v[136:139], v5, s[8:11], s40 offen offset:2048 sc1
buffer_load_dwordx4 v[140:143], v5, s[8:11], s41 offen offset:2048 sc1
s_barrier
ds_read_b128 v[144:147], v6 offset:8192
ds_read_b128 v[148:151], v6 offset:9216
ds_read_b128 v[152:155], v6 offset:10240
ds_read_b128 v[156:159], v6 offset:11264
ds_read_b128 v[160:163], v6 offset:12288
s_waitcnt vmcnt(18)
s_waitcnt lgkmcnt(4)
v_mfma_f32_16x16x32_bf16 v[204:207], v[144:147], v[64:67], 0
ds_read_b128 v[164:167], v6 offset:18432
v_mfma_f32_16x16x32_bf16 v[224:227], v[144:147], v[68:71], 0
s_waitcnt lgkmcnt(4)
v_mfma_f32_16x16x32_bf16 v[208:211], v[148:151], v[64:67], 0
ds_read_b128 v[168:171], v6 offset:19456
v_mfma_f32_16x16x32_bf16 v[228:231], v[148:151], v[68:71], 0
s_waitcnt lgkmcnt(4)
v_mfma_f32_16x16x32_bf16 v[212:215], v[152:155], v[64:67], 0
ds_read_b128 v[172:175], v6 offset:20480
v_mfma_f32_16x16x32_bf16 v[232:235], v[152:155], v[68:71], 0
s_waitcnt lgkmcnt(4)
v_mfma_f32_16x16x32_bf16 v[216:219], v[156:159], v[64:67], 0
ds_read_b128 v[176:179], v6 offset:21504
v_mfma_f32_16x16x32_bf16 v[236:239], v[156:159], v[68:71], 0
s_waitcnt lgkmcnt(4)
v_mfma_f32_16x16x32_bf16 v[220:223], v[160:163], v[64:67], 0
ds_read_b128 v[180:183], v6 offset:22528
v_mfma_f32_16x16x32_bf16 v[240:243], v[160:163], v[68:71], 0
s_waitcnt vmcnt(16)
s_waitcnt lgkmcnt(4)
v_mfma_f32_16x16x32_bf16 v[204:207], v[164:167], v[72:75], v[204:207]
ds_read_b128 v[144:147], v6 offset:28672
v_mfma_f32_16x16x32_bf16 v[224:227], v[164:167], v[76:79], v[224:227]
s_waitcnt lgkmcnt(4)
v_mfma_f32_16x16x32_bf16 v[208:211], v[168:171], v[72:75], v[208:211]
ds_read_b128 v[148:151], v6 offset:29696
v_mfma_f32_16x16x32_bf16 v[228:231], v[168:171], v[76:79], v[228:231]
s_waitcnt lgkmcnt(4)
v_mfma_f32_16x16x32_bf16 v[212:215], v[172:175], v[72:75], v[212:215]
ds_read_b128 v[152:155], v6 offset:30720
v_mfma_f32_16x16x32_bf16 v[232:235], v[172:175], v[76:79], v[232:235]
s_waitcnt lgkmcnt(4)
v_mfma_f32_16x16x32_bf16 v[216:219], v[176:179], v[72:75], v[216:219]
ds_read_b128 v[156:159], v6 offset:31744
v_mfma_f32_16x16x32_bf16 v[236:239], v[176:179], v[76:79], v[236:239]
s_waitcnt lgkmcnt(4)
v_mfma_f32_16x16x32_bf16 v[220:223], v[180:183], v[72:75], v[220:223]
ds_read_b128 v[160:163], v6 offset:32768
v_mfma_f32_16x16x32_bf16 v[240:243], v[180:183], v[76:79], v[240:243]
s_waitcnt vmcnt(14)
s_waitcnt lgkmcnt(4)
v_mfma_f32_16x16x32_bf16 v[204:207], v[144:147], v[80:83], v[204:207]
ds_read_b128 v[164:167], v6 offset:38912
v_mfma_f32_16x16x32_bf16 v[224:227], v[144:147], v[84:87], v[224:227]
s_waitcnt lgkmcnt(4)
v_mfma_f32_16x16x32_bf16 v[208:211], v[148:151], v[80:83], v[208:211]
ds_read_b128 v[168:171], v6 offset:39936
v_mfma_f32_16x16x32_bf16 v[228:231], v[148:151], v[84:87], v[228:231]
s_waitcnt lgkmcnt(4)
v_mfma_f32_16x16x32_bf16 v[212:215], v[152:155], v[80:83], v[212:215]
ds_read_b128 v[172:175], v6 offset:40960
v_mfma_f32_16x16x32_bf16 v[232:235], v[152:155], v[84:87], v[232:235]
s_waitcnt lgkmcnt(4)
v_mfma_f32_16x16x32_bf16 v[216:219], v[156:159], v[80:83], v[216:219]
ds_read_b128 v[176:179], v6 offset:41984
v_mfma_f32_16x16x32_bf16 v[236:239], v[156:159], v[84:87], v[236:239]
s_waitcnt lgkmcnt(4)
v_mfma_f32_16x16x32_bf16 v[220:223], v[160:163], v[80:83], v[220:223]
ds_read_b128 v[180:183], v6 offset:43008
v_mfma_f32_16x16x32_bf16 v[240:243], v[160:163], v[84:87], v[240:243]
s_waitcnt vmcnt(12)
s_waitcnt lgkmcnt(4)
v_mfma_f32_16x16x32_bf16 v[204:207], v[164:167], v[88:91], v[204:207]
ds_read_b128 v[144:147], v6 offset:49152
v_mfma_f32_16x16x32_bf16 v[224:227], v[164:167], v[92:95], v[224:227]
s_waitcnt lgkmcnt(4)
v_mfma_f32_16x16x32_bf16 v[208:211], v[168:171], v[88:91], v[208:211]
ds_read_b128 v[148:151], v6 offset:50176
v_mfma_f32_16x16x32_bf16 v[228:231], v[168:171], v[92:95], v[228:231]
s_waitcnt lgkmcnt(4)
v_mfma_f32_16x16x32_bf16 v[212:215], v[172:175], v[88:91], v[212:215]
ds_read_b128 v[152:155], v6 offset:51200
v_mfma_f32_16x16x32_bf16 v[232:235], v[172:175], v[92:95], v[232:235]
s_waitcnt lgkmcnt(4)
v_mfma_f32_16x16x32_bf16 v[216:219], v[176:179], v[88:91], v[216:219]
ds_read_b128 v[156:159], v6 offset:52224
v_mfma_f32_16x16x32_bf16 v[236:239], v[176:179], v[92:95], v[236:239]
s_waitcnt lgkmcnt(4)
v_mfma_f32_16x16x32_bf16 v[220:223], v[180:183], v[88:91], v[220:223]
ds_read_b128 v[160:163], v6 offset:53248
v_mfma_f32_16x16x32_bf16 v[240:243], v[180:183], v[92:95], v[240:243]
s_barrier
s_waitcnt vmcnt(10)
s_waitcnt lgkmcnt(4)
v_mfma_f32_16x16x32_bf16 v[204:207], v[144:147], v[96:99], v[204:207]
ds_read_b128 v[164:167], v6 offset:59392
v_mfma_f32_16x16x32_bf16 v[224:227], v[144:147], v[100:103], v[224:227]
s_waitcnt lgkmcnt(4)
v_mfma_f32_16x16x32_bf16 v[208:211], v[148:151], v[96:99], v[208:211]
ds_read_b128 v[168:171], v6 offset:60416
v_mfma_f32_16x16x32_bf16 v[228:231], v[148:151], v[100:103], v[228:231]
s_waitcnt lgkmcnt(4)
v_mfma_f32_16x16x32_bf16 v[212:215], v[152:155], v[96:99], v[212:215]
ds_read_b128 v[172:175], v6 offset:61440
v_mfma_f32_16x16x32_bf16 v[232:235], v[152:155], v[100:103], v[232:235]
s_waitcnt lgkmcnt(4)
v_mfma_f32_16x16x32_bf16 v[216:219], v[156:159], v[96:99], v[216:219]
ds_read_b128 v[176:179], v6 offset:62464
v_mfma_f32_16x16x32_bf16 v[236:239], v[156:159], v[100:103], v[236:239]
s_waitcnt lgkmcnt(4)
v_mfma_f32_16x16x32_bf16 v[220:223], v[160:163], v[96:99], v[220:223]
ds_read_b128 v[180:183], v6 offset:63488
v_mfma_f32_16x16x32_bf16 v[240:243], v[160:163], v[100:103], v[240:243]
s_waitcnt vmcnt(8)
s_waitcnt lgkmcnt(4)
v_mfma_f32_16x16x32_bf16 v[204:207], v[164:167], v[104:107], v[204:207]
ds_read_b128 v[144:147], v7 offset:4096
v_mfma_f32_16x16x32_bf16 v[224:227], v[164:167], v[108:111], v[224:227]
s_waitcnt lgkmcnt(4)
v_mfma_f32_16x16x32_bf16 v[208:211], v[168:171], v[104:107], v[208:211]
ds_read_b128 v[148:151], v7 offset:5120
v_mfma_f32_16x16x32_bf16 v[228:231], v[168:171], v[108:111], v[228:231]
s_waitcnt lgkmcnt(4)
v_mfma_f32_16x16x32_bf16 v[212:215], v[172:175], v[104:107], v[212:215]
ds_read_b128 v[152:155], v7 offset:6144
v_mfma_f32_16x16x32_bf16 v[232:235], v[172:175], v[108:111], v[232:235]
s_waitcnt lgkmcnt(4)
v_mfma_f32_16x16x32_bf16 v[216:219], v[176:179], v[104:107], v[216:219]
ds_read_b128 v[156:159], v7 offset:7168
v_mfma_f32_16x16x32_bf16 v[236:239], v[176:179], v[108:111], v[236:239]
s_waitcnt lgkmcnt(4)
v_mfma_f32_16x16x32_bf16 v[220:223], v[180:183], v[104:107], v[220:223]
ds_read_b128 v[160:163], v7 offset:8192
v_mfma_f32_16x16x32_bf16 v[240:243], v[180:183], v[108:111], v[240:243]
s_waitcnt vmcnt(6)
s_waitcnt lgkmcnt(4)
v_mfma_f32_16x16x32_bf16 v[204:207], v[144:147], v[112:115], v[204:207]
ds_read_b128 v[164:167], v7 offset:14336
v_mfma_f32_16x16x32_bf16 v[224:227], v[144:147], v[116:119], v[224:227]
s_waitcnt lgkmcnt(4)
v_mfma_f32_16x16x32_bf16 v[208:211], v[148:151], v[112:115], v[208:211]
ds_read_b128 v[168:171], v7 offset:15360
v_mfma_f32_16x16x32_bf16 v[228:231], v[148:151], v[116:119], v[228:231]
s_waitcnt lgkmcnt(4)
v_mfma_f32_16x16x32_bf16 v[212:215], v[152:155], v[112:115], v[212:215]
ds_read_b128 v[172:175], v7 offset:16384
v_mfma_f32_16x16x32_bf16 v[232:235], v[152:155], v[116:119], v[232:235]
s_waitcnt lgkmcnt(4)
v_mfma_f32_16x16x32_bf16 v[216:219], v[156:159], v[112:115], v[216:219]
ds_read_b128 v[176:179], v7 offset:17408
v_mfma_f32_16x16x32_bf16 v[236:239], v[156:159], v[116:119], v[236:239]
s_waitcnt lgkmcnt(4)
v_mfma_f32_16x16x32_bf16 v[220:223], v[160:163], v[112:115], v[220:223]
ds_read_b128 v[180:183], v7 offset:18432
v_mfma_f32_16x16x32_bf16 v[240:243], v[160:163], v[116:119], v[240:243]
s_waitcnt vmcnt(4)
s_waitcnt lgkmcnt(4)
v_mfma_f32_16x16x32_bf16 v[204:207], v[164:167], v[120:123], v[204:207]
ds_read_b128 v[144:147], v7 offset:24576
v_mfma_f32_16x16x32_bf16 v[224:227], v[164:167], v[124:127], v[224:227]
s_waitcnt lgkmcnt(4)
v_mfma_f32_16x16x32_bf16 v[208:211], v[168:171], v[120:123], v[208:211]
ds_read_b128 v[148:151], v7 offset:25600
v_mfma_f32_16x16x32_bf16 v[228:231], v[168:171], v[124:127], v[228:231]
s_waitcnt lgkmcnt(4)
v_mfma_f32_16x16x32_bf16 v[212:215], v[172:175], v[120:123], v[212:215]
ds_read_b128 v[152:155], v7 offset:26624
v_mfma_f32_16x16x32_bf16 v[232:235], v[172:175], v[124:127], v[232:235]
s_waitcnt lgkmcnt(4)
v_mfma_f32_16x16x32_bf16 v[216:219], v[176:179], v[120:123], v[216:219]
ds_read_b128 v[156:159], v7 offset:27648
v_mfma_f32_16x16x32_bf16 v[236:239], v[176:179], v[124:127], v[236:239]
s_waitcnt lgkmcnt(4)
v_mfma_f32_16x16x32_bf16 v[220:223], v[180:183], v[120:123], v[220:223]
ds_read_b128 v[160:163], v7 offset:28672
v_mfma_f32_16x16x32_bf16 v[240:243], v[180:183], v[124:127], v[240:243]
s_waitcnt vmcnt(2)
s_waitcnt lgkmcnt(4)
v_mfma_f32_16x16x32_bf16 v[204:207], v[144:147], v[128:131], v[204:207]
ds_read_b128 v[164:167], v7 offset:34816
v_mfma_f32_16x16x32_bf16 v[224:227], v[144:147], v[132:135], v[224:227]
s_waitcnt lgkmcnt(4)
v_mfma_f32_16x16x32_bf16 v[208:211], v[148:151], v[128:131], v[208:211]
ds_read_b128 v[168:171], v7 offset:35840
v_mfma_f32_16x16x32_bf16 v[228:231], v[148:151], v[132:135], v[228:231]
s_waitcnt lgkmcnt(4)
v_mfma_f32_16x16x32_bf16 v[212:215], v[152:155], v[128:131], v[212:215]
ds_read_b128 v[172:175], v7 offset:36864
v_mfma_f32_16x16x32_bf16 v[232:235], v[152:155], v[132:135], v[232:235]
s_waitcnt lgkmcnt(4)
v_mfma_f32_16x16x32_bf16 v[216:219], v[156:159], v[128:131], v[216:219]
ds_read_b128 v[176:179], v7 offset:37888
v_mfma_f32_16x16x32_bf16 v[236:239], v[156:159], v[132:135], v[236:239]
s_waitcnt lgkmcnt(4)
v_mfma_f32_16x16x32_bf16 v[220:223], v[160:163], v[128:131], v[220:223]
ds_read_b128 v[180:183], v7 offset:38912
v_mfma_f32_16x16x32_bf16 v[240:243], v[160:163], v[132:135], v[240:243]
s_waitcnt vmcnt(0)
s_waitcnt lgkmcnt(4)
v_mfma_f32_16x16x32_bf16 v[204:207], v[164:167], v[136:139], v[204:207]
v_mfma_f32_16x16x32_bf16 v[224:227], v[164:167], v[140:143], v[224:227]
s_waitcnt lgkmcnt(3)
v_mfma_f32_16x16x32_bf16 v[208:211], v[168:171], v[136:139], v[208:211]
v_mfma_f32_16x16x32_bf16 v[228:231], v[168:171], v[140:143], v[228:231]
s_waitcnt lgkmcnt(2)
v_mfma_f32_16x16x32_bf16 v[212:215], v[172:175], v[136:139], v[212:215]
v_mfma_f32_16x16x32_bf16 v[232:235], v[172:175], v[140:143], v[232:235]
s_waitcnt lgkmcnt(1)
v_mfma_f32_16x16x32_bf16 v[216:219], v[176:179], v[136:139], v[216:219]
v_mfma_f32_16x16x32_bf16 v[236:239], v[176:179], v[140:143], v[236:239]
s_waitcnt lgkmcnt(0)
v_mfma_f32_16x16x32_bf16 v[220:223], v[180:183], v[136:139], v[220:223]
v_mfma_f32_16x16x32_bf16 v[240:243], v[180:183], v[140:143], v[240:243]
s_and_b32 s45, s34, 3
s_lshl_b32 s44, s45, 13
s_add_u32 s44, s44, 114688
v_add_u32 v56, s44, v5
ds_write_b128 v56, v[224:227] offset:0
ds_write_b128 v56, v[228:231] offset:1024
ds_write_b128 v56, v[232:235] offset:2048
ds_write_b128 v56, v[236:239] offset:3072
ds_write_b128 v56, v[240:243] offset:4096
s_xor_b32 s45, s45, 1
s_lshl_b32 s44, s45, 13
s_add_u32 s44, s44, 114688
v_add_u32 v57, s44, v5
s_waitcnt lgkmcnt(0)
s_barrier
ds_read_b128 v[144:147], v57 offset:0
ds_read_b128 v[148:151], v57 offset:1024
ds_read_b128 v[152:155], v57 offset:2048
ds_read_b128 v[156:159], v57 offset:3072
ds_read_b128 v[160:163], v57 offset:4096
s_waitcnt lgkmcnt(0)
v_add_f32 v204, v204, v144
v_add_f32 v205, v205, v145
v_add_f32 v206, v206, v146
v_add_f32 v207, v207, v147
v_add_f32 v208, v208, v148
v_add_f32 v209, v209, v149
v_add_f32 v210, v210, v150
v_add_f32 v211, v211, v151
v_add_f32 v212, v212, v152
v_add_f32 v213, v213, v153
v_add_f32 v214, v214, v154
v_add_f32 v215, v215, v155
v_add_f32 v216, v216, v156
v_add_f32 v217, v217, v157
v_add_f32 v218, v218, v158
v_add_f32 v219, v219, v159
v_add_f32 v220, v220, v160
v_add_f32 v221, v221, v161
v_add_f32 v222, v222, v162
v_add_f32 v223, v223, v163
v_lshrrev_b32 v61, 1, v4
v_lshlrev_b32 v61, 8, v61
v_lshl_add_u32 v61, v3, 4, v61
s_lshl_b32 s45, s68, 9
v_add_u32 v61, s45, v61
v_and_b32 v62, 1, v4
v_lshl_add_u32 v60, v62, 9, v61
v_lshl_add_u32 v61, v62, 3, v61
s_mul_i32 s40, s67, 20480
s_mul_i32 s41, s65, 20480
s_mul_i32 s45, s37, 2621440
s_add_u32 s45, s45, 12201984
s_add_u32 s40, s40, s45
s_add_u32 s41, s41, s45
v_lshlrev_b32 v48, 16, v246
v_and_b32 v49, 0xffff0000, v246
v_lshlrev_b32 v50, 16, v247
v_and_b32 v51, 0xffff0000, v247
v_add_f32 v48, v48, v204
v_add_f32 v49, v49, v205
v_add_f32 v50, v50, v206
v_add_f32 v51, v51, v207
v_cvt_pk_bf16_f32 v246, v48, v49
v_cvt_pk_bf16_f32 v247, v50, v51
v_lshlrev_b32 v48, 16, v248
v_and_b32 v49, 0xffff0000, v248
v_lshlrev_b32 v50, 16, v249
v_and_b32 v51, 0xffff0000, v249
v_add_f32 v48, v48, v208
v_add_f32 v49, v49, v209
v_add_f32 v50, v50, v210
v_add_f32 v51, v51, v211
v_cvt_pk_bf16_f32 v248, v48, v49
v_cvt_pk_bf16_f32 v249, v50, v51
v_lshlrev_b32 v48, 16, v250
v_and_b32 v49, 0xffff0000, v250
v_lshlrev_b32 v50, 16, v251
v_and_b32 v51, 0xffff0000, v251
v_add_f32 v48, v48, v212
v_add_f32 v49, v49, v213
v_add_f32 v50, v50, v214
v_add_f32 v51, v51, v215
v_cvt_pk_bf16_f32 v250, v48, v49
v_cvt_pk_bf16_f32 v251, v50, v51
v_lshlrev_b32 v48, 16, v252
v_and_b32 v49, 0xffff0000, v252
v_lshlrev_b32 v50, 16, v253
v_and_b32 v51, 0xffff0000, v253
v_add_f32 v48, v48, v216
v_add_f32 v49, v49, v217
v_add_f32 v50, v50, v218
v_add_f32 v51, v51, v219
v_cvt_pk_bf16_f32 v252, v48, v49
v_cvt_pk_bf16_f32 v253, v50, v51
v_lshlrev_b32 v48, 16, v254
v_and_b32 v49, 0xffff0000, v254
v_lshlrev_b32 v50, 16, v255
v_and_b32 v51, 0xffff0000, v255
v_add_f32 v48, v48, v220
v_add_f32 v49, v49, v221
v_add_f32 v50, v50, v222
v_add_f32 v51, v51, v223
v_cvt_pk_bf16_f32 v254, v48, v49
v_cvt_pk_bf16_f32 v255, v50, v51
v_mov_b32 v48, v246
v_mov_b32 v49, v247
v_mov_b32 v50, v248
v_mov_b32 v51, v249
s_nop 0
v_permlane16_swap_b32 v48, v50
v_permlane16_swap_b32 v49, v51
v_mov_b32 v52, v250
v_mov_b32 v53, v251
v_mov_b32 v54, v252
v_mov_b32 v55, v253
s_nop 0
v_permlane16_swap_b32 v52, v54
v_permlane16_swap_b32 v53, v55
s_cmp_eq_u32 s59, 1
s_cbranch_scc1 xs_16
buffer_store_dwordx4 v[48:51], v60, s[8:11], s40 offen offset:0 sc1
buffer_store_dwordx4 v[52:55], v60, s[8:11], s40 offen offset:1024 sc1
buffer_store_dwordx2 v[254:255], v61, s[8:11], s40 offen offset:2048 sc1
s_branch xs_17
xs_16:
buffer_store_dwordx4 v[48:51], v60, s[8:11], s40 offen offset:0
buffer_store_dwordx4 v[52:55], v60, s[8:11], s40 offen offset:1024
buffer_store_dwordx2 v[254:255], v61, s[8:11], s40 offen offset:2048
xs_17:
s_barrier
s_lshl_b32 s46, s37, 13
s_lshl_b32 s45, s67, 6
s_add_u32 s46, s46, s45
s_add_u32 s46, s46, 6373376
s_lshl_b32 s45, s36, 2
s_add_u32 s46, s46, s45
s_waitcnt vmcnt(0)
v_mov_b32 v56, 0
v_mov_b32 v57, 1
s_mov_b64 s[42:43], exec
s_mov_b64 exec, 1
s_cmp_eq_u32 s59, 1
s_cbranch_scc1 sf_18
buffer_store_dword v57, v56, s[8:11], s46 offen sc1
s_branch sf_19
sf_18:
buffer_store_dword v57, v56, s[8:11], s46 offen
sf_19:
s_mov_b64 exec, s[42:43]
s_lshr_b32 s52, s36, 1
s_mul_i32 s52, s52, 27
s_and_b32 s53, s36, 1
s_mul_i32 s53, s53, 14
s_add_u32 s52, s52, s53
s_and_b32 s53, s34, 1
s_mul_i32 s53, s53, 7
s_add_u32 s52, s52, s53
s_mov_b32 s20, s24
s_mov_b32 s21, s25
s_mov_b32 s22, 3456
s_mov_b32 s23, 0x20000
s_lshl_b32 s47, s52, 5
v_lshlrev_b32 v60, 3, v4
v_add_u32 v60, s47, v60
buffer_load_dwordx2 v[232:233], v60, s[20:23], 0 offen offset:0
buffer_load_dwordx2 v[234:235], v60, s[20:23], 0 offen offset:32
buffer_load_dwordx2 v[236:237], v60, s[20:23], 0 offen offset:64
buffer_load_dwordx2 v[238:239], v60, s[20:23], 0 offen offset:96
buffer_load_dwordx2 v[240:241], v60, s[20:23], 0 offen offset:128
buffer_load_dwordx2 v[242:243], v60, s[20:23], 0 offen offset:160
buffer_load_dwordx2 v[244:245], v60, s[20:23], 0 offen offset:192
s_mul_i32 s45, s36, 896
s_lshl_b32 s44, s53, 6
s_add_u32 s45, s45, s44
s_add_u32 s45, s45, 6332416
v_lshlrev_b32 v58, 4, v4
buffer_load_dwordx4 v[8:11], v58, s[8:11], s45 offen offset:0
buffer_load_dwordx4 v[12:15], v58, s[8:11], s45 offen offset:64
buffer_load_dwordx4 v[16:19], v58, s[8:11], s45 offen offset:128
buffer_load_dwordx4 v[20:23], v58, s[8:11], s45 offen offset:192
buffer_load_dwordx4 v[24:27], v58, s[8:11], s45 offen offset:256
buffer_load_dwordx4 v[28:31], v58, s[8:11], s45 offen offset:320
buffer_load_dwordx4 v[32:35], v58, s[8:11], s45 offen offset:384
v_mov_b32 v52, 0x3f803f80
v_mov_b32 v53, 0x3f803f80
v_mov_b32 v54, 0x3f803f80
v_mov_b32 v55, 0x3f803f80
s_and_b32 s45, s34, 1
s_mul_i32 s44, s45, 7168
v_add_u32 v6, s44, v5
v_add_u32 v7, 0x10000, v6
v_add_u32 v59, 114688, v6
s_xor_b32 s45, s45, 1
s_mul_i32 s44, s45, 107520
v_add_u32 v2, s44, v5
s_lshl_b32 s46, s37, 13
s_and_b32 s45, s67, -2
s_lshl_b32 s45, s45, 6
s_add_u32 s46, s46, s45
s_add_u32 s46, s46, 6373376
v_lshlrev_b32 v56, 2, v1
s_mov_b64 s[42:43], exec
s_mov_b64 exec, 0xff00ff
s_mov_b32 s44, 0
poll_20:
buffer_load_dword v57, v56, s[8:11], s46 offen sc1
s_add_u32 s44, s44, 1
s_waitcnt vmcnt(0)
v_cmp_eq_u32 vcc, 0, v57
s_nop 2
s_cmp_eq_u64 vcc, 0
s_cbranch_scc1 polld_21
s_cmp_gt_u32 s44, 200000
s_cbranch_scc1 polld_21
s_sleep 1
s_branch poll_20
polld_21:
s_mov_b64 exec, s[42:43]
s_mul_i32 s40, s67, 20480
s_mul_i32 s41, s65, 20480
s_mul_i32 s45, s37, 2621440
s_add_u32 s45, s45, 12201984
s_add_u32 s40, s40, s45
s_add_u32 s41, s41, s45
buffer_load_dwordx4 v[64:67], v5, s[8:11], s40 offen offset:0 sc1
buffer_load_dwordx4 v[68:71], v5, s[8:11], s41 offen offset:0 sc1
buffer_load_dwordx4 v[72:75], v5, s[8:11], s40 offen offset:1024 sc1
buffer_load_dwordx4 v[76:79], v5, s[8:11], s41 offen offset:1024 sc1
buffer_load_dwordx4 v[80:83], v5, s[8:11], s40 offen offset:2048 sc1
buffer_load_dwordx4 v[84:87], v5, s[8:11], s41 offen offset:2048 sc1
buffer_load_dwordx4 v[88:91], v5, s[8:11], s40 offen offset:3072 sc1
buffer_load_dwordx4 v[92:95], v5, s[8:11], s41 offen offset:3072 sc1
s_add_u32 s40, s40, 4096
s_add_u32 s41, s41, 4096
buffer_load_dwordx4 v[96:99], v5, s[8:11], s40 offen offset:0 sc1
buffer_load_dwordx4 v[100:103], v5, s[8:11], s41 offen offset:0 sc1
buffer_load_dwordx4 v[104:107], v5, s[8:11], s40 offen offset:1024 sc1
buffer_load_dwordx4 v[108:111], v5, s[8:11], s41 offen offset:1024 sc1
buffer_load_dwordx4 v[112:115], v5, s[8:11], s40 offen offset:2048 sc1
buffer_load_dwordx4 v[116:119], v5, s[8:11], s41 offen offset:2048 sc1
buffer_load_dwordx4 v[120:123], v5, s[8:11], s40 offen offset:3072 sc1
buffer_load_dwordx4 v[124:127], v5, s[8:11], s41 offen offset:3072 sc1
s_add_u32 s40, s40, 4096
s_add_u32 s41, s41, 4096
buffer_load_dwordx4 v[128:131], v5, s[8:11], s40 offen offset:0 sc1
buffer_load_dwordx4 v[132:135], v5, s[8:11], s41 offen offset:0 sc1
buffer_load_dwordx4 v[136:139], v5, s[8:11], s40 offen offset:1024 sc1
buffer_load_dwordx4 v[140:143], v5, s[8:11], s41 offen offset:1024 sc1
s_barrier
s_mov_b32 s44, 117760
s_bitcmp1_b32 s34, 0
s_cselect_b32 s45, s44, 110592
v_add_u32 v58, s45, v5
ds_read_b128 v[144:147], v58
s_mov_b32 s44, 118784
s_bitcmp1_b32 s34, 0
s_cselect_b32 s45, s44, 111616
v_add_u32 v58, s45, v5
ds_read_b128 v[148:151], v58
s_mov_b32 s44, 119808
s_bitcmp1_b32 s34, 0
s_cselect_b32 s45, s44, 112640
v_add_u32 v58, s45, v5
ds_read_b128 v[152:155], v58
s_mov_b32 s44, 120832
s_bitcmp1_b32 s34, 0
s_cselect_b32 s45, s44, 113664
v_add_u32 v58, s45, v5
ds_read_b128 v[156:159], v58
s_waitcnt vmcnt(18)
s_waitcnt lgkmcnt(3)
v_mfma_f32_16x16x32_bf16 v[176:179], v[144:147], v[64:67], 0
ds_read_b128 v[160:163], v59 offset:0
v_mfma_f32_16x16x32_bf16 v[204:207], v[144:147], v[68:71], 0
s_waitcnt lgkmcnt(3)
v_mfma_f32_16x16x32_bf16 v[180:183], v[148:151], v[64:67], 0
ds_read_b128 v[164:167], v59 offset:1024
v_mfma_f32_16x16x32_bf16 v[208:211], v[148:151], v[68:71], 0
s_waitcnt lgkmcnt(3)
v_mfma_f32_16x16x32_bf16 v[184:187], v[152:155], v[64:67], 0
ds_read_b128 v[168:171], v59 offset:2048
v_mfma_f32_16x16x32_bf16 v[212:215], v[152:155], v[68:71], 0
s_waitcnt lgkmcnt(3)
v_mfma_f32_16x16x32_bf16 v[188:191], v[156:159], v[64:67], 0
v_mfma_f32_16x16x32_bf16 v[216:219], v[156:159], v[68:71], 0
s_waitcnt lgkmcnt(2)
v_mfma_f32_16x16x32_bf16 v[192:195], v[160:163], v[64:67], 0
ds_read_b128 v[144:147], v59 offset:10240
v_mfma_f32_16x16x32_bf16 v[220:223], v[160:163], v[68:71], 0
ds_read_b128 v[148:151], v59 offset:11264
s_waitcnt lgkmcnt(3)
v_mfma_f32_16x16x32_bf16 v[196:199], v[164:167], v[64:67], 0
ds_read_b128 v[152:155], v59 offset:12288
v_mfma_f32_16x16x32_bf16 v[224:227], v[164:167], v[68:71], 0
s_waitcnt lgkmcnt(3)
v_mfma_f32_16x16x32_bf16 v[200:203], v[168:171], v[64:67], 0
ds_read_b128 v[156:159], v59 offset:13312
v_mfma_f32_16x16x32_bf16 v[228:231], v[168:171], v[68:71], 0
v_mfma_f32_16x16x32_bf16 v[36:39], v[52:55], v[64:67], 0
v_mfma_f32_16x16x32_bf16 v[40:43], v[64:67], v[64:67], 0
buffer_load_dwordx4 v[64:67], v5, s[8:11], s40 offen offset:2048 sc1
buffer_load_dwordx4 v[68:71], v5, s[8:11], s41 offen offset:2048 sc1
s_waitcnt vmcnt(18)
s_waitcnt lgkmcnt(3)
v_mfma_f32_16x16x32_bf16 v[176:179], v[144:147], v[72:75], v[176:179]
ds_read_b128 v[160:163], v59 offset:14336
v_mfma_f32_16x16x32_bf16 v[204:207], v[144:147], v[76:79], v[204:207]
s_waitcnt lgkmcnt(3)
v_mfma_f32_16x16x32_bf16 v[180:183], v[148:151], v[72:75], v[180:183]
ds_read_b128 v[164:167], v59 offset:15360
v_mfma_f32_16x16x32_bf16 v[208:211], v[148:151], v[76:79], v[208:211]
s_waitcnt lgkmcnt(3)
v_mfma_f32_16x16x32_bf16 v[184:187], v[152:155], v[72:75], v[184:187]
ds_read_b128 v[168:171], v59 offset:16384
v_mfma_f32_16x16x32_bf16 v[212:215], v[152:155], v[76:79], v[212:215]
s_waitcnt lgkmcnt(3)
v_mfma_f32_16x16x32_bf16 v[188:191], v[156:159], v[72:75], v[188:191]
v_mfma_f32_16x16x32_bf16 v[216:219], v[156:159], v[76:79], v[216:219]
s_barrier
s_waitcnt lgkmcnt(2)
v_mfma_f32_16x16x32_bf16 v[192:195], v[160:163], v[72:75], v[192:195]
ds_read_b128 v[144:147], v59 offset:24576
v_mfma_f32_16x16x32_bf16 v[220:223], v[160:163], v[76:79], v[220:223]
ds_read_b128 v[148:151], v59 offset:25600
s_waitcnt lgkmcnt(3)
v_mfma_f32_16x16x32_bf16 v[196:199], v[164:167], v[72:75], v[196:199]
ds_read_b128 v[152:155], v59 offset:26624
v_mfma_f32_16x16x32_bf16 v[224:227], v[164:167], v[76:79], v[224:227]
s_waitcnt lgkmcnt(3)
v_mfma_f32_16x16x32_bf16 v[200:203], v[168:171], v[72:75], v[200:203]
ds_read_b128 v[156:159], v59 offset:27648
v_mfma_f32_16x16x32_bf16 v[228:231], v[168:171], v[76:79], v[228:231]
v_mfma_f32_16x16x32_bf16 v[36:39], v[52:55], v[72:75], v[36:39]
v_mfma_f32_16x16x32_bf16 v[40:43], v[72:75], v[72:75], v[40:43]
buffer_load_dwordx4 v[72:75], v5, s[8:11], s40 offen offset:3072 sc1
buffer_load_dwordx4 v[76:79], v5, s[8:11], s41 offen offset:3072 sc1
s_waitcnt vmcnt(18)
s_waitcnt lgkmcnt(3)
v_mfma_f32_16x16x32_bf16 v[176:179], v[144:147], v[80:83], v[176:179]
ds_read_b128 v[160:163], v59 offset:28672
v_mfma_f32_16x16x32_bf16 v[204:207], v[144:147], v[84:87], v[204:207]
s_waitcnt lgkmcnt(3)
v_mfma_f32_16x16x32_bf16 v[180:183], v[148:151], v[80:83], v[180:183]
ds_read_b128 v[164:167], v59 offset:29696
v_mfma_f32_16x16x32_bf16 v[208:211], v[148:151], v[84:87], v[208:211]
s_waitcnt lgkmcnt(3)
v_mfma_f32_16x16x32_bf16 v[184:187], v[152:155], v[80:83], v[184:187]
ds_read_b128 v[168:171], v59 offset:30720
v_mfma_f32_16x16x32_bf16 v[212:215], v[152:155], v[84:87], v[212:215]
s_waitcnt lgkmcnt(3)
v_mfma_f32_16x16x32_bf16 v[188:191], v[156:159], v[80:83], v[188:191]
v_mfma_f32_16x16x32_bf16 v[216:219], v[156:159], v[84:87], v[216:219]
s_waitcnt lgkmcnt(2)
v_mfma_f32_16x16x32_bf16 v[192:195], v[160:163], v[80:83], v[192:195]
ds_read_b128 v[144:147], v59 offset:38912
v_mfma_f32_16x16x32_bf16 v[220:223], v[160:163], v[84:87], v[220:223]
ds_read_b128 v[148:151], v59 offset:39936
s_waitcnt lgkmcnt(3)
v_mfma_f32_16x16x32_bf16 v[196:199], v[164:167], v[80:83], v[196:199]
ds_read_b128 v[152:155], v59 offset:40960
v_mfma_f32_16x16x32_bf16 v[224:227], v[164:167], v[84:87], v[224:227]
s_waitcnt lgkmcnt(3)
v_mfma_f32_16x16x32_bf16 v[200:203], v[168:171], v[80:83], v[200:203]
s_mov_b32 s44, 0
s_bitcmp1_b32 s34, 0
s_cselect_b32 s45, s44, 156672
v_add_u32 v58, s45, v5
ds_read_b128 v[156:159], v58
v_mfma_f32_16x16x32_bf16 v[228:231], v[168:171], v[84:87], v[228:231]
v_mfma_f32_16x16x32_bf16 v[36:39], v[52:55], v[80:83], v[36:39]
v_mfma_f32_16x16x32_bf16 v[40:43], v[80:83], v[80:83], v[40:43]
s_add_u32 s40, s40, 4096
s_add_u32 s41, s41, 4096
buffer_load_dwordx4 v[80:83], v5, s[8:11], s40 offen offset:0 sc1
buffer_load_dwordx4 v[84:87], v5, s[8:11], s41 offen offset:0 sc1
s_waitcnt vmcnt(18)
s_waitcnt lgkmcnt(3)
v_mfma_f32_16x16x32_bf16 v[176:179], v[144:147], v[88:91], v[176:179]
s_mov_b32 s44, 1024
s_bitcmp1_b32 s34, 0
s_cselect_b32 s45, s44, 157696
v_add_u32 v58, s45, v5
ds_read_b128 v[160:163], v58
v_mfma_f32_16x16x32_bf16 v[204:207], v[144:147], v[92:95], v[204:207]
s_waitcnt lgkmcnt(3)
v_mfma_f32_16x16x32_bf16 v[180:183], v[148:151], v[88:91], v[180:183]
s_mov_b32 s44, 2048
s_bitcmp1_b32 s34, 0
s_cselect_b32 s45, s44, 158720
v_add_u32 v58, s45, v5
ds_read_b128 v[164:167], v58
v_mfma_f32_16x16x32_bf16 v[208:211], v[148:151], v[92:95], v[208:211]
s_waitcnt lgkmcnt(3)
v_mfma_f32_16x16x32_bf16 v[184:187], v[152:155], v[88:91], v[184:187]
s_mov_b32 s44, 3072
s_bitcmp1_b32 s34, 0
s_cselect_b32 s45, s44, 159744
v_add_u32 v58, s45, v5
ds_read_b128 v[168:171], v58
v_mfma_f32_16x16x32_bf16 v[212:215], v[152:155], v[92:95], v[212:215]
s_waitcnt lgkmcnt(3)
v_mfma_f32_16x16x32_bf16 v[188:191], v[156:159], v[88:91], v[188:191]
v_mfma_f32_16x16x32_bf16 v[216:219], v[156:159], v[92:95], v[216:219]
s_barrier
s_waitcnt lgkmcnt(2)
v_mfma_f32_16x16x32_bf16 v[192:195], v[160:163], v[88:91], v[192:195]
ds_read_b128 v[144:147], v6 offset:4096
v_mfma_f32_16x16x32_bf16 v[220:223], v[160:163], v[92:95], v[220:223]
ds_read_b128 v[148:151], v6 offset:5120
s_waitcnt lgkmcnt(3)
v_mfma_f32_16x16x32_bf16 v[196:199], v[164:167], v[88:91], v[196:199]
ds_read_b128 v[152:155], v6 offset:6144
v_mfma_f32_16x16x32_bf16 v[224:227], v[164:167], v[92:95], v[224:227]
s_waitcnt lgkmcnt(3)
v_mfma_f32_16x16x32_bf16 v[200:203], v[168:171], v[88:91], v[200:203]
ds_read_b128 v[156:159], v6 offset:7168
v_mfma_f32_16x16x32_bf16 v[228:231], v[168:171], v[92:95], v[228:231]
v_mfma_f32_16x16x32_bf16 v[36:39], v[52:55], v[88:91], v[36:39]
v_mfma_f32_16x16x32_bf16 v[40:43], v[88:91], v[88:91], v[40:43]
buffer_load_dwordx4 v[88:91], v5, s[8:11], s40 offen offset:1024 sc1
buffer_load_dwordx4 v[92:95], v5, s[8:11], s41 offen offset:1024 sc1
s_waitcnt vmcnt(18)
s_waitcnt lgkmcnt(3)
v_mfma_f32_16x16x32_bf16 v[176:179], v[144:147], v[96:99], v[176:179]
ds_read_b128 v[160:163], v6 offset:8192
v_mfma_f32_16x16x32_bf16 v[204:207], v[144:147], v[100:103], v[204:207]
s_waitcnt lgkmcnt(3)
v_mfma_f32_16x16x32_bf16 v[180:183], v[148:151], v[96:99], v[180:183]
ds_read_b128 v[164:167], v6 offset:9216
v_mfma_f32_16x16x32_bf16 v[208:211], v[148:151], v[100:103], v[208:211]
s_waitcnt lgkmcnt(3)
v_mfma_f32_16x16x32_bf16 v[184:187], v[152:155], v[96:99], v[184:187]
ds_read_b128 v[168:171], v6 offset:10240
v_mfma_f32_16x16x32_bf16 v[212:215], v[152:155], v[100:103], v[212:215]
s_waitcnt lgkmcnt(3)
v_mfma_f32_16x16x32_bf16 v[188:191], v[156:159], v[96:99], v[188:191]
v_mfma_f32_16x16x32_bf16 v[216:219], v[156:159], v[100:103], v[216:219]
s_waitcnt lgkmcnt(2)
v_mfma_f32_16x16x32_bf16 v[192:195], v[160:163], v[96:99], v[192:195]
ds_read_b128 v[144:147], v6 offset:18432
v_mfma_f32_16x16x32_bf16 v[220:223], v[160:163], v[100:103], v[220:223]
ds_read_b128 v[148:151], v6 offset:19456
s_waitcnt lgkmcnt(3)
v_mfma_f32_16x16x32_bf16 v[196:199], v[164:167], v[96:99], v[196:199]
ds_read_b128 v[152:155], v6 offset:20480
v_mfma_f32_16x16x32_bf16 v[224:227], v[164:167], v[100:103], v[224:227]
s_waitcnt lgkmcnt(3)
v_mfma_f32_16x16x32_bf16 v[200:203], v[168:171], v[96:99], v[200:203]
ds_read_b128 v[156:159], v6 offset:21504
v_mfma_f32_16x16x32_bf16 v[228:231], v[168:171], v[100:103], v[228:231]
v_mfma_f32_16x16x32_bf16 v[36:39], v[52:55], v[96:99], v[36:39]
v_mfma_f32_16x16x32_bf16 v[40:43], v[96:99], v[96:99], v[40:43]
buffer_load_dwordx4 v[96:99], v5, s[8:11], s40 offen offset:2048 sc1
buffer_load_dwordx4 v[100:103], v5, s[8:11], s41 offen offset:2048 sc1
s_waitcnt vmcnt(18)
s_waitcnt lgkmcnt(3)
v_mfma_f32_16x16x32_bf16 v[176:179], v[144:147], v[104:107], v[176:179]
ds_read_b128 v[160:163], v6 offset:22528
v_mfma_f32_16x16x32_bf16 v[204:207], v[144:147], v[108:111], v[204:207]
s_waitcnt lgkmcnt(3)
v_mfma_f32_16x16x32_bf16 v[180:183], v[148:151], v[104:107], v[180:183]
ds_read_b128 v[164:167], v6 offset:23552
v_mfma_f32_16x16x32_bf16 v[208:211], v[148:151], v[108:111], v[208:211]
s_waitcnt lgkmcnt(3)
v_mfma_f32_16x16x32_bf16 v[184:187], v[152:155], v[104:107], v[184:187]
ds_read_b128 v[168:171], v6 offset:24576
v_mfma_f32_16x16x32_bf16 v[212:215], v[152:155], v[108:111], v[212:215]
s_waitcnt lgkmcnt(3)
v_mfma_f32_16x16x32_bf16 v[188:191], v[156:159], v[104:107], v[188:191]
v_mfma_f32_16x16x32_bf16 v[216:219], v[156:159], v[108:111], v[216:219]
s_barrier
s_waitcnt lgkmcnt(2)
v_mfma_f32_16x16x32_bf16 v[192:195], v[160:163], v[104:107], v[192:195]
ds_read_b128 v[144:147], v6 offset:32768
v_mfma_f32_16x16x32_bf16 v[220:223], v[160:163], v[108:111], v[220:223]
ds_read_b128 v[148:151], v6 offset:33792
s_waitcnt lgkmcnt(3)
v_mfma_f32_16x16x32_bf16 v[196:199], v[164:167], v[104:107], v[196:199]
ds_read_b128 v[152:155], v6 offset:34816
v_mfma_f32_16x16x32_bf16 v[224:227], v[164:167], v[108:111], v[224:227]
s_waitcnt lgkmcnt(3)
v_mfma_f32_16x16x32_bf16 v[200:203], v[168:171], v[104:107], v[200:203]
ds_read_b128 v[156:159], v6 offset:35840
v_mfma_f32_16x16x32_bf16 v[228:231], v[168:171], v[108:111], v[228:231]
v_mfma_f32_16x16x32_bf16 v[36:39], v[52:55], v[104:107], v[36:39]
v_mfma_f32_16x16x32_bf16 v[40:43], v[104:107], v[104:107], v[40:43]
buffer_load_dwordx4 v[104:107], v5, s[8:11], s40 offen offset:3072 sc1
buffer_load_dwordx4 v[108:111], v5, s[8:11], s41 offen offset:3072 sc1
s_waitcnt vmcnt(18)
s_waitcnt lgkmcnt(3)
v_mfma_f32_16x16x32_bf16 v[176:179], v[144:147], v[112:115], v[176:179]
ds_read_b128 v[160:163], v6 offset:36864
v_mfma_f32_16x16x32_bf16 v[204:207], v[144:147], v[116:119], v[204:207]
s_waitcnt lgkmcnt(3)
v_mfma_f32_16x16x32_bf16 v[180:183], v[148:151], v[112:115], v[180:183]
ds_read_b128 v[164:167], v6 offset:37888
v_mfma_f32_16x16x32_bf16 v[208:211], v[148:151], v[116:119], v[208:211]
s_waitcnt lgkmcnt(3)
v_mfma_f32_16x16x32_bf16 v[184:187], v[152:155], v[112:115], v[184:187]
ds_read_b128 v[168:171], v6 offset:38912
v_mfma_f32_16x16x32_bf16 v[212:215], v[152:155], v[116:119], v[212:215]
s_waitcnt lgkmcnt(3)
v_mfma_f32_16x16x32_bf16 v[188:191], v[156:159], v[112:115], v[188:191]
v_mfma_f32_16x16x32_bf16 v[216:219], v[156:159], v[116:119], v[216:219]
s_waitcnt lgkmcnt(2)
v_mfma_f32_16x16x32_bf16 v[192:195], v[160:163], v[112:115], v[192:195]
ds_read_b128 v[144:147], v6 offset:47104
v_mfma_f32_16x16x32_bf16 v[220:223], v[160:163], v[116:119], v[220:223]
ds_read_b128 v[148:151], v6 offset:48128
s_waitcnt lgkmcnt(3)
v_mfma_f32_16x16x32_bf16 v[196:199], v[164:167], v[112:115], v[196:199]
ds_read_b128 v[152:155], v6 offset:49152
v_mfma_f32_16x16x32_bf16 v[224:227], v[164:167], v[116:119], v[224:227]
s_waitcnt lgkmcnt(3)
v_mfma_f32_16x16x32_bf16 v[200:203], v[168:171], v[112:115], v[200:203]
ds_read_b128 v[156:159], v6 offset:50176
v_mfma_f32_16x16x32_bf16 v[228:231], v[168:171], v[116:119], v[228:231]
v_mfma_f32_16x16x32_bf16 v[36:39], v[52:55], v[112:115], v[36:39]
v_mfma_f32_16x16x32_bf16 v[40:43], v[112:115], v[112:115], v[40:43]
s_add_u32 s40, s40, 4096
s_add_u32 s41, s41, 4096
buffer_load_dwordx4 v[112:115], v5, s[8:11], s40 offen offset:0 sc1
buffer_load_dwordx4 v[116:119], v5, s[8:11], s41 offen offset:0 sc1
s_waitcnt vmcnt(18)
s_waitcnt lgkmcnt(3)
v_mfma_f32_16x16x32_bf16 v[176:179], v[144:147], v[120:123], v[176:179]
ds_read_b128 v[160:163], v6 offset:51200
v_mfma_f32_16x16x32_bf16 v[204:207], v[144:147], v[124:127], v[204:207]
s_waitcnt lgkmcnt(3)
v_mfma_f32_16x16x32_bf16 v[180:183], v[148:151], v[120:123], v[180:183]
ds_read_b128 v[164:167], v6 offset:52224
v_mfma_f32_16x16x32_bf16 v[208:211], v[148:151], v[124:127], v[208:211]
s_waitcnt lgkmcnt(3)
v_mfma_f32_16x16x32_bf16 v[184:187], v[152:155], v[120:123], v[184:187]
ds_read_b128 v[168:171], v6 offset:53248
v_mfma_f32_16x16x32_bf16 v[212:215], v[152:155], v[124:127], v[212:215]
s_waitcnt lgkmcnt(3)
v_mfma_f32_16x16x32_bf16 v[188:191], v[156:159], v[120:123], v[188:191]
v_mfma_f32_16x16x32_bf16 v[216:219], v[156:159], v[124:127], v[216:219]
s_barrier
s_waitcnt lgkmcnt(2)
v_mfma_f32_16x16x32_bf16 v[192:195], v[160:163], v[120:123], v[192:195]
ds_read_b128 v[144:147], v6 offset:61440
v_mfma_f32_16x16x32_bf16 v[220:223], v[160:163], v[124:127], v[220:223]
ds_read_b128 v[148:151], v6 offset:62464
s_waitcnt lgkmcnt(3)
v_mfma_f32_16x16x32_bf16 v[196:199], v[164:167], v[120:123], v[196:199]
ds_read_b128 v[152:155], v6 offset:63488
v_mfma_f32_16x16x32_bf16 v[224:227], v[164:167], v[124:127], v[224:227]
s_waitcnt lgkmcnt(3)
v_mfma_f32_16x16x32_bf16 v[200:203], v[168:171], v[120:123], v[200:203]
ds_read_b128 v[156:159], v6 offset:64512
v_mfma_f32_16x16x32_bf16 v[228:231], v[168:171], v[124:127], v[228:231]
v_mfma_f32_16x16x32_bf16 v[36:39], v[52:55], v[120:123], v[36:39]
v_mfma_f32_16x16x32_bf16 v[40:43], v[120:123], v[120:123], v[40:43]
buffer_load_dwordx4 v[120:123], v5, s[8:11], s40 offen offset:1024 sc1
buffer_load_dwordx4 v[124:127], v5, s[8:11], s41 offen offset:1024 sc1
s_waitcnt vmcnt(18)
s_waitcnt lgkmcnt(3)
v_mfma_f32_16x16x32_bf16 v[176:179], v[144:147], v[128:131], v[176:179]
ds_read_b128 v[160:163], v7 offset:0
v_mfma_f32_16x16x32_bf16 v[204:207], v[144:147], v[132:135], v[204:207]
s_waitcnt lgkmcnt(3)
v_mfma_f32_16x16x32_bf16 v[180:183], v[148:151], v[128:131], v[180:183]
ds_read_b128 v[164:167], v7 offset:1024
v_mfma_f32_16x16x32_bf16 v[208:211], v[148:151], v[132:135], v[208:211]
s_waitcnt lgkmcnt(3)
v_mfma_f32_16x16x32_bf16 v[184:187], v[152:155], v[128:131], v[184:187]
ds_read_b128 v[168:171], v7 offset:2048
v_mfma_f32_16x16x32_bf16 v[212:215], v[152:155], v[132:135], v[212:215]
s_waitcnt lgkmcnt(3)
v_mfma_f32_16x16x32_bf16 v[188:191], v[156:159], v[128:131], v[188:191]
v_mfma_f32_16x16x32_bf16 v[216:219], v[156:159], v[132:135], v[216:219]
s_waitcnt lgkmcnt(2)
v_mfma_f32_16x16x32_bf16 v[192:195], v[160:163], v[128:131], v[192:195]
ds_read_b128 v[144:147], v7 offset:10240
v_mfma_f32_16x16x32_bf16 v[220:223], v[160:163], v[132:135], v[220:223]
ds_read_b128 v[148:151], v7 offset:11264
s_waitcnt lgkmcnt(3)
v_mfma_f32_16x16x32_bf16 v[196:199], v[164:167], v[128:131], v[196:199]
ds_read_b128 v[152:155], v7 offset:12288
v_mfma_f32_16x16x32_bf16 v[224:227], v[164:167], v[132:135], v[224:227]
s_waitcnt lgkmcnt(3)
v_mfma_f32_16x16x32_bf16 v[200:203], v[168:171], v[128:131], v[200:203]
ds_read_b128 v[156:159], v7 offset:13312
v_mfma_f32_16x16x32_bf16 v[228:231], v[168:171], v[132:135], v[228:231]
v_mfma_f32_16x16x32_bf16 v[36:39], v[52:55], v[128:131], v[36:39]
v_mfma_f32_16x16x32_bf16 v[40:43], v[128:131], v[128:131], v[40:43]
buffer_load_dwordx4 v[128:131], v5, s[8:11], s40 offen offset:2048 sc1
buffer_load_dwordx4 v[132:135], v5, s[8:11], s41 offen offset:2048 sc1
s_waitcnt vmcnt(18)
s_waitcnt lgkmcnt(3)
v_mfma_f32_16x16x32_bf16 v[176:179], v[144:147], v[136:139], v[176:179]
ds_read_b128 v[160:163], v7 offset:14336
v_mfma_f32_16x16x32_bf16 v[204:207], v[144:147], v[140:143], v[204:207]
s_waitcnt lgkmcnt(3)
v_mfma_f32_16x16x32_bf16 v[180:183], v[148:151], v[136:139], v[180:183]
ds_read_b128 v[164:167], v7 offset:15360
v_mfma_f32_16x16x32_bf16 v[208:211], v[148:151], v[140:143], v[208:211]
s_waitcnt lgkmcnt(3)
v_mfma_f32_16x16x32_bf16 v[184:187], v[152:155], v[136:139], v[184:187]
ds_read_b128 v[168:171], v7 offset:16384
v_mfma_f32_16x16x32_bf16 v[212:215], v[152:155], v[140:143], v[212:215]
s_waitcnt lgkmcnt(3)
v_mfma_f32_16x16x32_bf16 v[188:191], v[156:159], v[136:139], v[188:191]
v_mfma_f32_16x16x32_bf16 v[216:219], v[156:159], v[140:143], v[216:219]
s_barrier
s_waitcnt lgkmcnt(2)
v_mfma_f32_16x16x32_bf16 v[192:195], v[160:163], v[136:139], v[192:195]
ds_read_b128 v[144:147], v7 offset:24576
v_mfma_f32_16x16x32_bf16 v[220:223], v[160:163], v[140:143], v[220:223]
ds_read_b128 v[148:151], v7 offset:25600
s_waitcnt lgkmcnt(3)
v_mfma_f32_16x16x32_bf16 v[196:199], v[164:167], v[136:139], v[196:199]
ds_read_b128 v[152:155], v7 offset:26624
v_mfma_f32_16x16x32_bf16 v[224:227], v[164:167], v[140:143], v[224:227]
s_waitcnt lgkmcnt(3)
v_mfma_f32_16x16x32_bf16 v[200:203], v[168:171], v[136:139], v[200:203]
ds_read_b128 v[156:159], v7 offset:27648
v_mfma_f32_16x16x32_bf16 v[228:231], v[168:171], v[140:143], v[228:231]
v_mfma_f32_16x16x32_bf16 v[36:39], v[52:55], v[136:139], v[36:39]
v_mfma_f32_16x16x32_bf16 v[40:43], v[136:139], v[136:139], v[40:43]
buffer_load_dwordx4 v[136:139], v5, s[8:11], s40 offen offset:3072 sc1
buffer_load_dwordx4 v[140:143], v5, s[8:11], s41 offen offset:3072 sc1
s_waitcnt vmcnt(18)
s_waitcnt lgkmcnt(3)
v_mfma_f32_16x16x32_bf16 v[176:179], v[144:147], v[64:67], v[176:179]
ds_read_b128 v[160:163], v7 offset:28672
v_mfma_f32_16x16x32_bf16 v[204:207], v[144:147], v[68:71], v[204:207]
s_waitcnt lgkmcnt(3)
v_mfma_f32_16x16x32_bf16 v[180:183], v[148:151], v[64:67], v[180:183]
ds_read_b128 v[164:167], v7 offset:29696
v_mfma_f32_16x16x32_bf16 v[208:211], v[148:151], v[68:71], v[208:211]
s_waitcnt lgkmcnt(3)
v_mfma_f32_16x16x32_bf16 v[184:187], v[152:155], v[64:67], v[184:187]
ds_read_b128 v[168:171], v7 offset:30720
v_mfma_f32_16x16x32_bf16 v[212:215], v[152:155], v[68:71], v[212:215]
s_waitcnt lgkmcnt(3)
v_mfma_f32_16x16x32_bf16 v[188:191], v[156:159], v[64:67], v[188:191]
v_mfma_f32_16x16x32_bf16 v[216:219], v[156:159], v[68:71], v[216:219]
s_waitcnt lgkmcnt(2)
v_mfma_f32_16x16x32_bf16 v[192:195], v[160:163], v[64:67], v[192:195]
ds_read_b128 v[144:147], v7 offset:38912
v_mfma_f32_16x16x32_bf16 v[220:223], v[160:163], v[68:71], v[220:223]
ds_read_b128 v[148:151], v7 offset:39936
s_waitcnt lgkmcnt(3)
v_mfma_f32_16x16x32_bf16 v[196:199], v[164:167], v[64:67], v[196:199]
ds_read_b128 v[152:155], v7 offset:40960
v_mfma_f32_16x16x32_bf16 v[224:227], v[164:167], v[68:71], v[224:227]
s_waitcnt lgkmcnt(3)
v_mfma_f32_16x16x32_bf16 v[200:203], v[168:171], v[64:67], v[200:203]
ds_read_b128 v[156:159], v2 offset:0
v_mfma_f32_16x16x32_bf16 v[228:231], v[168:171], v[68:71], v[228:231]
v_mfma_f32_16x16x32_bf16 v[36:39], v[52:55], v[64:67], v[36:39]
v_mfma_f32_16x16x32_bf16 v[40:43], v[64:67], v[64:67], v[40:43]
s_waitcnt vmcnt(16)
s_waitcnt lgkmcnt(3)
v_mfma_f32_16x16x32_bf16 v[176:179], v[144:147], v[72:75], v[176:179]
ds_read_b128 v[160:163], v2 offset:1024
v_mfma_f32_16x16x32_bf16 v[204:207], v[144:147], v[76:79], v[204:207]
s_waitcnt lgkmcnt(3)
v_mfma_f32_16x16x32_bf16 v[180:183], v[148:151], v[72:75], v[180:183]
ds_read_b128 v[164:167], v2 offset:2048
v_mfma_f32_16x16x32_bf16 v[208:211], v[148:151], v[76:79], v[208:211]
s_waitcnt lgkmcnt(3)
v_mfma_f32_16x16x32_bf16 v[184:187], v[152:155], v[72:75], v[184:187]
ds_read_b128 v[168:171], v2 offset:3072
v_mfma_f32_16x16x32_bf16 v[212:215], v[152:155], v[76:79], v[212:215]
s_waitcnt lgkmcnt(3)
v_mfma_f32_16x16x32_bf16 v[188:191], v[156:159], v[72:75], v[188:191]
v_mfma_f32_16x16x32_bf16 v[216:219], v[156:159], v[76:79], v[216:219]
s_barrier
s_waitcnt lgkmcnt(2)
v_mfma_f32_16x16x32_bf16 v[192:195], v[160:163], v[72:75], v[192:195]
ds_read_b128 v[144:147], v6 offset:4096
v_mfma_f32_16x16x32_bf16 v[220:223], v[160:163], v[76:79], v[220:223]
ds_read_b128 v[148:151], v6 offset:5120
s_waitcnt lgkmcnt(3)
v_mfma_f32_16x16x32_bf16 v[196:199], v[164:167], v[72:75], v[196:199]
ds_read_b128 v[152:155], v6 offset:6144
v_mfma_f32_16x16x32_bf16 v[224:227], v[164:167], v[76:79], v[224:227]
s_waitcnt lgkmcnt(3)
v_mfma_f32_16x16x32_bf16 v[200:203], v[168:171], v[72:75], v[200:203]
ds_read_b128 v[156:159], v6 offset:7168
v_mfma_f32_16x16x32_bf16 v[228:231], v[168:171], v[76:79], v[228:231]
v_mfma_f32_16x16x32_bf16 v[36:39], v[52:55], v[72:75], v[36:39]
v_mfma_f32_16x16x32_bf16 v[40:43], v[72:75], v[72:75], v[40:43]
s_waitcnt vmcnt(14)
s_waitcnt lgkmcnt(3)
v_mfma_f32_16x16x32_bf16 v[176:179], v[144:147], v[80:83], v[176:179]
ds_read_b128 v[160:163], v6 offset:8192
v_mfma_f32_16x16x32_bf16 v[204:207], v[144:147], v[84:87], v[204:207]
s_waitcnt lgkmcnt(3)
v_mfma_f32_16x16x32_bf16 v[180:183], v[148:151], v[80:83], v[180:183]
ds_read_b128 v[164:167], v6 offset:9216
v_mfma_f32_16x16x32_bf16 v[208:211], v[148:151], v[84:87], v[208:211]
s_waitcnt lgkmcnt(3)
v_mfma_f32_16x16x32_bf16 v[184:187], v[152:155], v[80:83], v[184:187]
ds_read_b128 v[168:171], v6 offset:10240
v_mfma_f32_16x16x32_bf16 v[212:215], v[152:155], v[84:87], v[212:215]
s_waitcnt lgkmcnt(3)
v_mfma_f32_16x16x32_bf16 v[188:191], v[156:159], v[80:83], v[188:191]
v_mfma_f32_16x16x32_bf16 v[216:219], v[156:159], v[84:87], v[216:219]
s_waitcnt lgkmcnt(2)
v_mfma_f32_16x16x32_bf16 v[192:195], v[160:163], v[80:83], v[192:195]
ds_read_b128 v[144:147], v6 offset:18432
v_mfma_f32_16x16x32_bf16 v[220:223], v[160:163], v[84:87], v[220:223]
ds_read_b128 v[148:151], v6 offset:19456
s_waitcnt lgkmcnt(3)
v_mfma_f32_16x16x32_bf16 v[196:199], v[164:167], v[80:83], v[196:199]
ds_read_b128 v[152:155], v6 offset:20480
v_mfma_f32_16x16x32_bf16 v[224:227], v[164:167], v[84:87], v[224:227]
s_waitcnt lgkmcnt(3)
v_mfma_f32_16x16x32_bf16 v[200:203], v[168:171], v[80:83], v[200:203]
ds_read_b128 v[156:159], v6 offset:21504
v_mfma_f32_16x16x32_bf16 v[228:231], v[168:171], v[84:87], v[228:231]
v_mfma_f32_16x16x32_bf16 v[36:39], v[52:55], v[80:83], v[36:39]
v_mfma_f32_16x16x32_bf16 v[40:43], v[80:83], v[80:83], v[40:43]
s_waitcnt vmcnt(12)
s_waitcnt lgkmcnt(3)
v_mfma_f32_16x16x32_bf16 v[176:179], v[144:147], v[88:91], v[176:179]
ds_read_b128 v[160:163], v6 offset:22528
v_mfma_f32_16x16x32_bf16 v[204:207], v[144:147], v[92:95], v[204:207]
s_waitcnt lgkmcnt(3)
v_mfma_f32_16x16x32_bf16 v[180:183], v[148:151], v[88:91], v[180:183]
ds_read_b128 v[164:167], v6 offset:23552
v_mfma_f32_16x16x32_bf16 v[208:211], v[148:151], v[92:95], v[208:211]
s_waitcnt lgkmcnt(3)
v_mfma_f32_16x16x32_bf16 v[184:187], v[152:155], v[88:91], v[184:187]
ds_read_b128 v[168:171], v6 offset:24576
v_mfma_f32_16x16x32_bf16 v[212:215], v[152:155], v[92:95], v[212:215]
s_waitcnt lgkmcnt(3)
v_mfma_f32_16x16x32_bf16 v[188:191], v[156:159], v[88:91], v[188:191]
v_mfma_f32_16x16x32_bf16 v[216:219], v[156:159], v[92:95], v[216:219]
s_barrier
s_waitcnt lgkmcnt(2)
v_mfma_f32_16x16x32_bf16 v[192:195], v[160:163], v[88:91], v[192:195]
ds_read_b128 v[144:147], v6 offset:32768
v_mfma_f32_16x16x32_bf16 v[220:223], v[160:163], v[92:95], v[220:223]
ds_read_b128 v[148:151], v6 offset:33792
s_waitcnt lgkmcnt(3)
v_mfma_f32_16x16x32_bf16 v[196:199], v[164:167], v[88:91], v[196:199]
ds_read_b128 v[152:155], v6 offset:34816
v_mfma_f32_16x16x32_bf16 v[224:227], v[164:167], v[92:95], v[224:227]
s_waitcnt lgkmcnt(3)
v_mfma_f32_16x16x32_bf16 v[200:203], v[168:171], v[88:91], v[200:203]
ds_read_b128 v[156:159], v6 offset:35840
v_mfma_f32_16x16x32_bf16 v[228:231], v[168:171], v[92:95], v[228:231]
v_mfma_f32_16x16x32_bf16 v[36:39], v[52:55], v[88:91], v[36:39]
v_mfma_f32_16x16x32_bf16 v[40:43], v[88:91], v[88:91], v[40:43]
s_waitcnt vmcnt(10)
s_waitcnt lgkmcnt(3)
v_mfma_f32_16x16x32_bf16 v[176:179], v[144:147], v[96:99], v[176:179]
ds_read_b128 v[160:163], v6 offset:36864
v_mfma_f32_16x16x32_bf16 v[204:207], v[144:147], v[100:103], v[204:207]
s_waitcnt lgkmcnt(3)
v_mfma_f32_16x16x32_bf16 v[180:183], v[148:151], v[96:99], v[180:183]
ds_read_b128 v[164:167], v6 offset:37888
v_mfma_f32_16x16x32_bf16 v[208:211], v[148:151], v[100:103], v[208:211]
s_waitcnt lgkmcnt(3)
v_mfma_f32_16x16x32_bf16 v[184:187], v[152:155], v[96:99], v[184:187]
ds_read_b128 v[168:171], v6 offset:38912
v_mfma_f32_16x16x32_bf16 v[212:215], v[152:155], v[100:103], v[212:215]
s_waitcnt lgkmcnt(3)
v_mfma_f32_16x16x32_bf16 v[188:191], v[156:159], v[96:99], v[188:191]
v_mfma_f32_16x16x32_bf16 v[216:219], v[156:159], v[100:103], v[216:219]
s_waitcnt lgkmcnt(2)
v_mfma_f32_16x16x32_bf16 v[192:195], v[160:163], v[96:99], v[192:195]
ds_read_b128 v[144:147], v6 offset:47104
v_mfma_f32_16x16x32_bf16 v[220:223], v[160:163], v[100:103], v[220:223]
ds_read_b128 v[148:151], v6 offset:48128
s_waitcnt lgkmcnt(3)
v_mfma_f32_16x16x32_bf16 v[196:199], v[164:167], v[96:99], v[196:199]
ds_read_b128 v[152:155], v6 offset:49152
v_mfma_f32_16x16x32_bf16 v[224:227], v[164:167], v[100:103], v[224:227]
s_waitcnt lgkmcnt(3)
v_mfma_f32_16x16x32_bf16 v[200:203], v[168:171], v[96:99], v[200:203]
ds_read_b128 v[156:159], v6 offset:50176
v_mfma_f32_16x16x32_bf16 v[228:231], v[168:171], v[100:103], v[228:231]
v_mfma_f32_16x16x32_bf16 v[36:39], v[52:55], v[96:99], v[36:39]
v_mfma_f32_16x16x32_bf16 v[40:43], v[96:99], v[96:99], v[40:43]
s_waitcnt vmcnt(8)
s_waitcnt lgkmcnt(3)
v_mfma_f32_16x16x32_bf16 v[176:179], v[144:147], v[104:107], v[176:179]
ds_read_b128 v[160:163], v6 offset:51200
v_mfma_f32_16x16x32_bf16 v[204:207], v[144:147], v[108:111], v[204:207]
s_waitcnt lgkmcnt(3)
v_mfma_f32_16x16x32_bf16 v[180:183], v[148:151], v[104:107], v[180:183]
ds_read_b128 v[164:167], v6 offset:52224
v_mfma_f32_16x16x32_bf16 v[208:211], v[148:151], v[108:111], v[208:211]
s_waitcnt lgkmcnt(3)
v_mfma_f32_16x16x32_bf16 v[184:187], v[152:155], v[104:107], v[184:187]
ds_read_b128 v[168:171], v6 offset:53248
v_mfma_f32_16x16x32_bf16 v[212:215], v[152:155], v[108:111], v[212:215]
s_waitcnt lgkmcnt(3)
v_mfma_f32_16x16x32_bf16 v[188:191], v[156:159], v[104:107], v[188:191]
v_mfma_f32_16x16x32_bf16 v[216:219], v[156:159], v[108:111], v[216:219]
s_barrier
s_waitcnt lgkmcnt(2)
v_mfma_f32_16x16x32_bf16 v[192:195], v[160:163], v[104:107], v[192:195]
ds_read_b128 v[144:147], v6 offset:61440
v_mfma_f32_16x16x32_bf16 v[220:223], v[160:163], v[108:111], v[220:223]
ds_read_b128 v[148:151], v6 offset:62464
s_waitcnt lgkmcnt(3)
v_mfma_f32_16x16x32_bf16 v[196:199], v[164:167], v[104:107], v[196:199]
ds_read_b128 v[152:155], v6 offset:63488
v_mfma_f32_16x16x32_bf16 v[224:227], v[164:167], v[108:111], v[224:227]
s_waitcnt lgkmcnt(3)
v_mfma_f32_16x16x32_bf16 v[200:203], v[168:171], v[104:107], v[200:203]
ds_read_b128 v[156:159], v6 offset:64512
v_mfma_f32_16x16x32_bf16 v[228:231], v[168:171], v[108:111], v[228:231]
v_mfma_f32_16x16x32_bf16 v[36:39], v[52:55], v[104:107], v[36:39]
v_mfma_f32_16x16x32_bf16 v[40:43], v[104:107], v[104:107], v[40:43]
s_waitcnt vmcnt(6)
s_waitcnt lgkmcnt(3)
v_mfma_f32_16x16x32_bf16 v[176:179], v[144:147], v[112:115], v[176:179]
ds_read_b128 v[160:163], v7 offset:0
v_mfma_f32_16x16x32_bf16 v[204:207], v[144:147], v[116:119], v[204:207]
s_waitcnt lgkmcnt(3)
v_mfma_f32_16x16x32_bf16 v[180:183], v[148:151], v[112:115], v[180:183]
ds_read_b128 v[164:167], v7 offset:1024
v_mfma_f32_16x16x32_bf16 v[208:211], v[148:151], v[116:119], v[208:211]
s_waitcnt lgkmcnt(3)
v_mfma_f32_16x16x32_bf16 v[184:187], v[152:155], v[112:115], v[184:187]
ds_read_b128 v[168:171], v7 offset:2048
v_mfma_f32_16x16x32_bf16 v[212:215], v[152:155], v[116:119], v[212:215]
s_waitcnt lgkmcnt(3)
v_mfma_f32_16x16x32_bf16 v[188:191], v[156:159], v[112:115], v[188:191]
v_mfma_f32_16x16x32_bf16 v[216:219], v[156:159], v[116:119], v[216:219]
s_waitcnt lgkmcnt(2)
v_mfma_f32_16x16x32_bf16 v[192:195], v[160:163], v[112:115], v[192:195]
ds_read_b128 v[144:147], v7 offset:10240
v_mfma_f32_16x16x32_bf16 v[220:223], v[160:163], v[116:119], v[220:223]
ds_read_b128 v[148:151], v7 offset:11264
s_waitcnt lgkmcnt(3)
v_mfma_f32_16x16x32_bf16 v[196:199], v[164:167], v[112:115], v[196:199]
ds_read_b128 v[152:155], v7 offset:12288
v_mfma_f32_16x16x32_bf16 v[224:227], v[164:167], v[116:119], v[224:227]
s_waitcnt lgkmcnt(3)
v_mfma_f32_16x16x32_bf16 v[200:203], v[168:171], v[112:115], v[200:203]
ds_read_b128 v[156:159], v7 offset:13312
v_mfma_f32_16x16x32_bf16 v[228:231], v[168:171], v[116:119], v[228:231]
v_mfma_f32_16x16x32_bf16 v[36:39], v[52:55], v[112:115], v[36:39]
v_mfma_f32_16x16x32_bf16 v[40:43], v[112:115], v[112:115], v[40:43]
s_waitcnt vmcnt(4)
s_waitcnt lgkmcnt(3)
v_mfma_f32_16x16x32_bf16 v[176:179], v[144:147], v[120:123], v[176:179]
ds_read_b128 v[160:163], v7 offset:14336
v_mfma_f32_16x16x32_bf16 v[204:207], v[144:147], v[124:127], v[204:207]
s_waitcnt lgkmcnt(3)
v_mfma_f32_16x16x32_bf16 v[180:183], v[148:151], v[120:123], v[180:183]
ds_read_b128 v[164:167], v7 offset:15360
v_mfma_f32_16x16x32_bf16 v[208:211], v[148:151], v[124:127], v[208:211]
s_waitcnt lgkmcnt(3)
v_mfma_f32_16x16x32_bf16 v[184:187], v[152:155], v[120:123], v[184:187]
ds_read_b128 v[168:171], v7 offset:16384
v_mfma_f32_16x16x32_bf16 v[212:215], v[152:155], v[124:127], v[212:215]
s_waitcnt lgkmcnt(3)
v_mfma_f32_16x16x32_bf16 v[188:191], v[156:159], v[120:123], v[188:191]
v_mfma_f32_16x16x32_bf16 v[216:219], v[156:159], v[124:127], v[216:219]
s_barrier
s_waitcnt lgkmcnt(2)
v_mfma_f32_16x16x32_bf16 v[192:195], v[160:163], v[120:123], v[192:195]
ds_read_b128 v[144:147], v7 offset:24576
v_mfma_f32_16x16x32_bf16 v[220:223], v[160:163], v[124:127], v[220:223]
ds_read_b128 v[148:151], v7 offset:25600
s_waitcnt lgkmcnt(3)
v_mfma_f32_16x16x32_bf16 v[196:199], v[164:167], v[120:123], v[196:199]
ds_read_b128 v[152:155], v7 offset:26624
v_mfma_f32_16x16x32_bf16 v[224:227], v[164:167], v[124:127], v[224:227]
s_waitcnt lgkmcnt(3)
v_mfma_f32_16x16x32_bf16 v[200:203], v[168:171], v[120:123], v[200:203]
ds_read_b128 v[156:159], v7 offset:27648
v_mfma_f32_16x16x32_bf16 v[228:231], v[168:171], v[124:127], v[228:231]
v_mfma_f32_16x16x32_bf16 v[36:39], v[52:55], v[120:123], v[36:39]
v_mfma_f32_16x16x32_bf16 v[40:43], v[120:123], v[120:123], v[40:43]
s_waitcnt vmcnt(2)
s_waitcnt lgkmcnt(3)
v_mfma_f32_16x16x32_bf16 v[176:179], v[144:147], v[128:131], v[176:179]
ds_read_b128 v[160:163], v7 offset:28672
v_mfma_f32_16x16x32_bf16 v[204:207], v[144:147], v[132:135], v[204:207]
s_waitcnt lgkmcnt(3)
v_mfma_f32_16x16x32_bf16 v[180:183], v[148:151], v[128:131], v[180:183]
ds_read_b128 v[164:167], v7 offset:29696
v_mfma_f32_16x16x32_bf16 v[208:211], v[148:151], v[132:135], v[208:211]
s_waitcnt lgkmcnt(3)
v_mfma_f32_16x16x32_bf16 v[184:187], v[152:155], v[128:131], v[184:187]
ds_read_b128 v[168:171], v7 offset:30720
v_mfma_f32_16x16x32_bf16 v[212:215], v[152:155], v[132:135], v[212:215]
s_waitcnt lgkmcnt(3)
v_mfma_f32_16x16x32_bf16 v[188:191], v[156:159], v[128:131], v[188:191]
v_mfma_f32_16x16x32_bf16 v[216:219], v[156:159], v[132:135], v[216:219]
s_waitcnt lgkmcnt(2)
v_mfma_f32_16x16x32_bf16 v[192:195], v[160:163], v[128:131], v[192:195]
ds_read_b128 v[144:147], v7 offset:38912
v_mfma_f32_16x16x32_bf16 v[220:223], v[160:163], v[132:135], v[220:223]
ds_read_b128 v[148:151], v7 offset:39936
s_waitcnt lgkmcnt(3)
v_mfma_f32_16x16x32_bf16 v[196:199], v[164:167], v[128:131], v[196:199]
ds_read_b128 v[152:155], v7 offset:40960
v_mfma_f32_16x16x32_bf16 v[224:227], v[164:167], v[132:135], v[224:227]
s_waitcnt lgkmcnt(3)
v_mfma_f32_16x16x32_bf16 v[200:203], v[168:171], v[128:131], v[200:203]
ds_read_b128 v[156:159], v2 offset:0
v_mfma_f32_16x16x32_bf16 v[228:231], v[168:171], v[132:135], v[228:231]
v_mfma_f32_16x16x32_bf16 v[36:39], v[52:55], v[128:131], v[36:39]
v_mfma_f32_16x16x32_bf16 v[40:43], v[128:131], v[128:131], v[40:43]
s_waitcnt vmcnt(0)
s_waitcnt lgkmcnt(3)
v_mfma_f32_16x16x32_bf16 v[176:179], v[144:147], v[136:139], v[176:179]
ds_read_b128 v[160:163], v2 offset:1024
v_mfma_f32_16x16x32_bf16 v[204:207], v[144:147], v[140:143], v[204:207]
s_waitcnt lgkmcnt(3)
v_mfma_f32_16x16x32_bf16 v[180:183], v[148:151], v[136:139], v[180:183]
ds_read_b128 v[164:167], v2 offset:2048
v_mfma_f32_16x16x32_bf16 v[208:211], v[148:151], v[140:143], v[208:211]
s_waitcnt lgkmcnt(3)
v_mfma_f32_16x16x32_bf16 v[184:187], v[152:155], v[136:139], v[184:187]
ds_read_b128 v[168:171], v2 offset:3072
v_mfma_f32_16x16x32_bf16 v[212:215], v[152:155], v[140:143], v[212:215]
s_waitcnt lgkmcnt(3)
v_mfma_f32_16x16x32_bf16 v[188:191], v[156:159], v[136:139], v[188:191]
v_mfma_f32_16x16x32_bf16 v[216:219], v[156:159], v[140:143], v[216:219]
s_waitcnt lgkmcnt(2)
v_mfma_f32_16x16x32_bf16 v[192:195], v[160:163], v[136:139], v[192:195]
v_mfma_f32_16x16x32_bf16 v[220:223], v[160:163], v[140:143], v[220:223]
s_waitcnt lgkmcnt(1)
v_mfma_f32_16x16x32_bf16 v[196:199], v[164:167], v[136:139], v[196:199]
v_mfma_f32_16x16x32_bf16 v[224:227], v[164:167], v[140:143], v[224:227]
s_waitcnt lgkmcnt(0)
v_mfma_f32_16x16x32_bf16 v[200:203], v[168:171], v[136:139], v[200:203]
v_mfma_f32_16x16x32_bf16 v[228:231], v[168:171], v[140:143], v[228:231]
v_mfma_f32_16x16x32_bf16 v[36:39], v[52:55], v[136:139], v[36:39]
v_mfma_f32_16x16x32_bf16 v[40:43], v[136:139], v[136:139], v[40:43]
v_and_b32 v56, 3, v1
s_nop 6
v_mov_b32 v57, v40
v_cmp_eq_u32 vcc, 1, v56
s_nop 1
v_cndmask_b32 v57, v57, v41, vcc
v_cmp_eq_u32 vcc, 2, v56
s_nop 1
v_cndmask_b32 v57, v57, v42, vcc
v_cmp_eq_u32 vcc, 3, v56
s_nop 1
v_cndmask_b32 v57, v57, v43, vcc
v_lshrrev_b32 v58, 2, v3
v_lshlrev_b32 v58, 4, v58
v_add_u32 v58, v58, v3
v_lshlrev_b32 v58, 2, v58
ds_bpermute_b32 v57, v58, v57
v_mul_f32 v56, 0x3acccccd, v36
s_waitcnt lgkmcnt(0)
v_mul_f32 v57, 0x3acccccd, v57
v_fma_f32 v57, -v56, v56, v57
v_max_f32 v57, 0, v57
v_add_f32 v58, 0x3727c5ac, v57
v_rsq_f32 v58, v58
s_nop 0
v_mul_f32 v59, v58, v58
v_mul_f32 v59, v59, v57
v_add_f32 v59, 0x3727c5ac, v59
v_rsq_f32 v59, v59
s_nop 0
v_mul_f32 v58, v58, v59
v_mov_b32 v60, v58
v_mul_f32 v61, v56, v58
s_and_b32 s45, s34, 3
s_lshl_b32 s44, s45, 9
s_add_u32 s44, s44, 114688
v_lshlrev_b32 v56, 3, v1
v_add_u32 v57, s44, v56
ds_write_b64 v57, v[60:61]
s_xor_b32 s45, s45, 1
s_lshl_b32 s44, s45, 9
s_add_u32 s44, s44, 114688
v_add_u32 v57, s44, v56
s_waitcnt lgkmcnt(0)
s_barrier
ds_read_b64 v[62:63], v57
s_waitcnt lgkmcnt(0)
s_barrier
v_lshrrev_b32 v59, 1, v4
v_lshlrev_b32 v59, 8, v59
v_lshl_add_u32 v59, v3, 4, v59
s_lshl_b32 s45, s52, 9
v_add_u32 v59, s45, v59
v_and_b32 v56, 1, v4
v_lshl_add_u32 v58, v56, 9, v59
v_lshl_add_u32 v59, v56, 3, v59
s_mul_i32 s40, s67, 55296
s_mul_i32 s41, s65, 55296
s_mul_i32 s45, s37, 7077888
s_add_u32 s45, s45, 17444864
s_add_u32 s40, s40, s45
s_add_u32 s41, s41, s45
v_mov_b32 v40, 0xc0135761
v_mov_b32 v41, v40
v_mov_b32 v42, 0xbdd2d3e8
v_mov_b32 v43, v42
v_mov_b32 v46, 1.0
v_mov_b32 v47, 1.0
s_waitcnt lgkmcnt(0)
v_mov_b32 v36, v60
v_mov_b32 v37, v60
v_sub_f32 v38, 0, v61
v_mov_b32 v39, v38
v_lshlrev_b32 v52, 16, v232
v_and_b32 v53, 0xffff0000, v232
v_lshlrev_b32 v54, 16, v233
v_and_b32 v55, 0xffff0000, v233
v_pk_fma_f32 v[52:53], v[38:39], v[8:9], v[52:53]
v_pk_fma_f32 v[54:55], v[38:39], v[10:11], v[54:55]
v_pk_fma_f32 v[52:53], v[36:37], v[176:177], v[52:53]
v_pk_fma_f32 v[54:55], v[36:37], v[178:179], v[54:55]
v_pk_mul_f32 v[144:145], v[52:53], v[52:53]
v_pk_mul_f32 v[146:147], v[54:55], v[54:55]
v_pk_fma_f32 v[144:145], v[144:145], v[42:43], v[40:41]
v_pk_fma_f32 v[146:147], v[146:147], v[42:43], v[40:41]
v_pk_mul_f32 v[144:145], v[144:145], v[52:53]
v_pk_mul_f32 v[146:147], v[146:147], v[54:55]
v_exp_f32 v144, v144
v_exp_f32 v145, v145
v_exp_f32 v146, v146
v_exp_f32 v147, v147
v_pk_add_f32 v[144:145], v[144:145], v[46:47]
v_pk_add_f32 v[146:147], v[146:147], v[46:47]
v_rcp_f32 v144, v144
v_rcp_f32 v145, v145
v_rcp_f32 v146, v146
v_rcp_f32 v147, v147
v_pk_mul_f32 v[52:53], v[52:53], v[144:145]
v_pk_mul_f32 v[54:55], v[54:55], v[146:147]
v_cvt_pk_bf16_f32 v152, v52, v53
v_cvt_pk_bf16_f32 v153, v54, v55
v_lshlrev_b32 v52, 16, v234
v_and_b32 v53, 0xffff0000, v234
v_lshlrev_b32 v54, 16, v235
v_and_b32 v55, 0xffff0000, v235
v_pk_fma_f32 v[52:53], v[38:39], v[12:13], v[52:53]
v_pk_fma_f32 v[54:55], v[38:39], v[14:15], v[54:55]
v_pk_fma_f32 v[52:53], v[36:37], v[180:181], v[52:53]
v_pk_fma_f32 v[54:55], v[36:37], v[182:183], v[54:55]
v_pk_mul_f32 v[144:145], v[52:53], v[52:53]
v_pk_mul_f32 v[146:147], v[54:55], v[54:55]
v_pk_fma_f32 v[144:145], v[144:145], v[42:43], v[40:41]
v_pk_fma_f32 v[146:147], v[146:147], v[42:43], v[40:41]
v_pk_mul_f32 v[144:145], v[144:145], v[52:53]
v_pk_mul_f32 v[146:147], v[146:147], v[54:55]
v_exp_f32 v144, v144
v_exp_f32 v145, v145
v_exp_f32 v146, v146
v_exp_f32 v147, v147
v_pk_add_f32 v[144:145], v[144:145], v[46:47]
v_pk_add_f32 v[146:147], v[146:147], v[46:47]
v_rcp_f32 v144, v144
v_rcp_f32 v145, v145
v_rcp_f32 v146, v146
v_rcp_f32 v147, v147
v_pk_mul_f32 v[52:53], v[52:53], v[144:145]
v_pk_mul_f32 v[54:55], v[54:55], v[146:147]
v_cvt_pk_bf16_f32 v154, v52, v53
v_cvt_pk_bf16_f32 v155, v54, v55
s_nop 0
v_permlane16_swap_b32 v152, v154
v_permlane16_swap_b32 v153, v155
s_cmp_eq_u32 s59, 1
s_cbranch_scc1 xs_22
buffer_store_dwordx4 v[152:155], v58, s[8:11], s40 offen offset:0 sc1
s_branch xs_23
xs_22:
buffer_store_dwordx4 v[152:155], v58, s[8:11], s40 offen offset:0
xs_23:
v_lshlrev_b32 v52, 16, v236
v_and_b32 v53, 0xffff0000, v236
v_lshlrev_b32 v54, 16, v237
v_and_b32 v55, 0xffff0000, v237
v_pk_fma_f32 v[52:53], v[38:39], v[16:17], v[52:53]
v_pk_fma_f32 v[54:55], v[38:39], v[18:19], v[54:55]
v_pk_fma_f32 v[52:53], v[36:37], v[184:185], v[52:53]
v_pk_fma_f32 v[54:55], v[36:37], v[186:187], v[54:55]
v_pk_mul_f32 v[144:145], v[52:53], v[52:53]
v_pk_mul_f32 v[146:147], v[54:55], v[54:55]
v_pk_fma_f32 v[144:145], v[144:145], v[42:43], v[40:41]
v_pk_fma_f32 v[146:147], v[146:147], v[42:43], v[40:41]
v_pk_mul_f32 v[144:145], v[144:145], v[52:53]
v_pk_mul_f32 v[146:147], v[146:147], v[54:55]
v_exp_f32 v144, v144
v_exp_f32 v145, v145
v_exp_f32 v146, v146
v_exp_f32 v147, v147
v_pk_add_f32 v[144:145], v[144:145], v[46:47]
v_pk_add_f32 v[146:147], v[146:147], v[46:47]
v_rcp_f32 v144, v144
v_rcp_f32 v145, v145
v_rcp_f32 v146, v146
v_rcp_f32 v147, v147
v_pk_mul_f32 v[52:53], v[52:53], v[144:145]
v_pk_mul_f32 v[54:55], v[54:55], v[146:147]
v_cvt_pk_bf16_f32 v156, v52, v53
v_cvt_pk_bf16_f32 v157, v54, v55
v_lshlrev_b32 v52, 16, v238
v_and_b32 v53, 0xffff0000, v238
v_lshlrev_b32 v54, 16, v239
v_and_b32 v55, 0xffff0000, v239
v_pk_fma_f32 v[52:53], v[38:39], v[20:21], v[52:53]
v_pk_fma_f32 v[54:55], v[38:39], v[22:23], v[54:55]
v_pk_fma_f32 v[52:53], v[36:37], v[188:189], v[52:53]
v_pk_fma_f32 v[54:55], v[36:37], v[190:191], v[54:55]
v_pk_mul_f32 v[144:145], v[52:53], v[52:53]
v_pk_mul_f32 v[146:147], v[54:55], v[54:55]
v_pk_fma_f32 v[144:145], v[144:145], v[42:43], v[40:41]
v_pk_fma_f32 v[146:147], v[146:147], v[42:43], v[40:41]
v_pk_mul_f32 v[144:145], v[144:145], v[52:53]
v_pk_mul_f32 v[146:147], v[146:147], v[54:55]
v_exp_f32 v144, v144
v_exp_f32 v145, v145
v_exp_f32 v146, v146
v_exp_f32 v147, v147
v_pk_add_f32 v[144:145], v[144:145], v[46:47]
v_pk_add_f32 v[146:147], v[146:147], v[46:47]
v_rcp_f32 v144, v144
v_rcp_f32 v145, v145
v_rcp_f32 v146, v146
v_rcp_f32 v147, v147
v_pk_mul_f32 v[52:53], v[52:53], v[144:145]
v_pk_mul_f32 v[54:55], v[54:55], v[146:147]
v_cvt_pk_bf16_f32 v158, v52, v53
v_cvt_pk_bf16_f32 v159, v54, v55
s_nop 0
v_permlane16_swap_b32 v156, v158
v_permlane16_swap_b32 v157, v159
s_cmp_eq_u32 s59, 1
s_cbranch_scc1 xs_24
buffer_store_dwordx4 v[156:159], v58, s[8:11], s40 offen offset:1024 sc1
s_branch xs_25
xs_24:
buffer_store_dwordx4 v[156:159], v58, s[8:11], s40 offen offset:1024
xs_25:
v_lshlrev_b32 v52, 16, v240
v_and_b32 v53, 0xffff0000, v240
v_lshlrev_b32 v54, 16, v241
v_and_b32 v55, 0xffff0000, v241
v_pk_fma_f32 v[52:53], v[38:39], v[24:25], v[52:53]
v_pk_fma_f32 v[54:55], v[38:39], v[26:27], v[54:55]
v_pk_fma_f32 v[52:53], v[36:37], v[192:193], v[52:53]
v_pk_fma_f32 v[54:55], v[36:37], v[194:195], v[54:55]
v_pk_mul_f32 v[144:145], v[52:53], v[52:53]
v_pk_mul_f32 v[146:147], v[54:55], v[54:55]
v_pk_fma_f32 v[144:145], v[144:145], v[42:43], v[40:41]
v_pk_fma_f32 v[146:147], v[146:147], v[42:43], v[40:41]
v_pk_mul_f32 v[144:145], v[144:145], v[52:53]
v_pk_mul_f32 v[146:147], v[146:147], v[54:55]
v_exp_f32 v144, v144
v_exp_f32 v145, v145
v_exp_f32 v146, v146
v_exp_f32 v147, v147
v_pk_add_f32 v[144:145], v[144:145], v[46:47]
v_pk_add_f32 v[146:147], v[146:147], v[46:47]
v_rcp_f32 v144, v144
v_rcp_f32 v145, v145
v_rcp_f32 v146, v146
v_rcp_f32 v147, v147
v_pk_mul_f32 v[52:53], v[52:53], v[144:145]
v_pk_mul_f32 v[54:55], v[54:55], v[146:147]
v_cvt_pk_bf16_f32 v152, v52, v53
v_cvt_pk_bf16_f32 v153, v54, v55
v_lshlrev_b32 v52, 16, v242
v_and_b32 v53, 0xffff0000, v242
v_lshlrev_b32 v54, 16, v243
v_and_b32 v55, 0xffff0000, v243
v_pk_fma_f32 v[52:53], v[38:39], v[28:29], v[52:53]
v_pk_fma_f32 v[54:55], v[38:39], v[30:31], v[54:55]
v_pk_fma_f32 v[52:53], v[36:37], v[196:197], v[52:53]
v_pk_fma_f32 v[54:55], v[36:37], v[198:199], v[54:55]
v_pk_mul_f32 v[144:145], v[52:53], v[52:53]
v_pk_mul_f32 v[146:147], v[54:55], v[54:55]
v_pk_fma_f32 v[144:145], v[144:145], v[42:43], v[40:41]
v_pk_fma_f32 v[146:147], v[146:147], v[42:43], v[40:41]
v_pk_mul_f32 v[144:145], v[144:145], v[52:53]
v_pk_mul_f32 v[146:147], v[146:147], v[54:55]
v_exp_f32 v144, v144
v_exp_f32 v145, v145
v_exp_f32 v146, v146
v_exp_f32 v147, v147
v_pk_add_f32 v[144:145], v[144:145], v[46:47]
v_pk_add_f32 v[146:147], v[146:147], v[46:47]
v_rcp_f32 v144, v144
v_rcp_f32 v145, v145
v_rcp_f32 v146, v146
v_rcp_f32 v147, v147
v_pk_mul_f32 v[52:53], v[52:53], v[144:145]
v_pk_mul_f32 v[54:55], v[54:55], v[146:147]
v_cvt_pk_bf16_f32 v154, v52, v53
v_cvt_pk_bf16_f32 v155, v54, v55
s_nop 0
v_permlane16_swap_b32 v152, v154
v_permlane16_swap_b32 v153, v155
s_cmp_eq_u32 s59, 1
s_cbranch_scc1 xs_26
buffer_store_dwordx4 v[152:155], v58, s[8:11], s40 offen offset:2048 sc1
s_branch xs_27
xs_26:
buffer_store_dwordx4 v[152:155], v58, s[8:11], s40 offen offset:2048
xs_27:
s_and_b32 s45, s36, s34
s_bitcmp1_b32 s45, 0
s_cbranch_scc1 fc1sk_28
v_lshlrev_b32 v52, 16, v244
v_and_b32 v53, 0xffff0000, v244
v_lshlrev_b32 v54, 16, v245
v_and_b32 v55, 0xffff0000, v245
v_pk_fma_f32 v[52:53], v[38:39], v[32:33], v[52:53]
v_pk_fma_f32 v[54:55], v[38:39], v[34:35], v[54:55]
v_pk_fma_f32 v[52:53], v[36:37], v[200:201], v[52:53]
v_pk_fma_f32 v[54:55], v[36:37], v[202:203], v[54:55]
v_pk_mul_f32 v[144:145], v[52:53], v[52:53]
v_pk_mul_f32 v[146:147], v[54:55], v[54:55]
v_pk_fma_f32 v[144:145], v[144:145], v[42:43], v[40:41]
v_pk_fma_f32 v[146:147], v[146:147], v[42:43], v[40:41]
v_pk_mul_f32 v[144:145], v[144:145], v[52:53]
v_pk_mul_f32 v[146:147], v[146:147], v[54:55]
v_exp_f32 v144, v144
v_exp_f32 v145, v145
v_exp_f32 v146, v146
v_exp_f32 v147, v147
v_pk_add_f32 v[144:145], v[144:145], v[46:47]
v_pk_add_f32 v[146:147], v[146:147], v[46:47]
v_rcp_f32 v144, v144
v_rcp_f32 v145, v145
v_rcp_f32 v146, v146
v_rcp_f32 v147, v147
v_pk_mul_f32 v[52:53], v[52:53], v[144:145]
v_pk_mul_f32 v[54:55], v[54:55], v[146:147]
v_cvt_pk_bf16_f32 v160, v52, v53
v_cvt_pk_bf16_f32 v161, v54, v55
s_cmp_eq_u32 s59, 1
s_cbranch_scc1 xs_29
buffer_store_dwordx2 v[160:161], v59, s[8:11], s40 offen offset:3072 sc1
s_branch xs_30
xs_29:
buffer_store_dwordx2 v[160:161], v59, s[8:11], s40 offen offset:3072
xs_30:
fc1sk_28:
v_mov_b32 v36, v62
v_mov_b32 v37, v62
v_sub_f32 v38, 0, v63
v_mov_b32 v39, v38
v_lshlrev_b32 v52, 16, v232
v_and_b32 v53, 0xffff0000, v232
v_lshlrev_b32 v54, 16, v233
v_and_b32 v55, 0xffff0000, v233
v_pk_fma_f32 v[52:53], v[38:39], v[8:9], v[52:53]
v_pk_fma_f32 v[54:55], v[38:39], v[10:11], v[54:55]
v_pk_fma_f32 v[52:53], v[36:37], v[204:205], v[52:53]
v_pk_fma_f32 v[54:55], v[36:37], v[206:207], v[54:55]
v_pk_mul_f32 v[144:145], v[52:53], v[52:53]
v_pk_mul_f32 v[146:147], v[54:55], v[54:55]
v_pk_fma_f32 v[144:145], v[144:145], v[42:43], v[40:41]
v_pk_fma_f32 v[146:147], v[146:147], v[42:43], v[40:41]
v_pk_mul_f32 v[144:145], v[144:145], v[52:53]
v_pk_mul_f32 v[146:147], v[146:147], v[54:55]
v_exp_f32 v144, v144
v_exp_f32 v145, v145
v_exp_f32 v146, v146
v_exp_f32 v147, v147
v_pk_add_f32 v[144:145], v[144:145], v[46:47]
v_pk_add_f32 v[146:147], v[146:147], v[46:47]
v_rcp_f32 v144, v144
v_rcp_f32 v145, v145
v_rcp_f32 v146, v146
v_rcp_f32 v147, v147
v_pk_mul_f32 v[52:53], v[52:53], v[144:145]
v_pk_mul_f32 v[54:55], v[54:55], v[146:147]
v_cvt_pk_bf16_f32 v152, v52, v53
v_cvt_pk_bf16_f32 v153, v54, v55
v_lshlrev_b32 v52, 16, v234
v_and_b32 v53, 0xffff0000, v234
v_lshlrev_b32 v54, 16, v235
v_and_b32 v55, 0xffff0000, v235
v_pk_fma_f32 v[52:53], v[38:39], v[12:13], v[52:53]
v_pk_fma_f32 v[54:55], v[38:39], v[14:15], v[54:55]
v_pk_fma_f32 v[52:53], v[36:37], v[208:209], v[52:53]
v_pk_fma_f32 v[54:55], v[36:37], v[210:211], v[54:55]
v_pk_mul_f32 v[144:145], v[52:53], v[52:53]
v_pk_mul_f32 v[146:147], v[54:55], v[54:55]
v_pk_fma_f32 v[144:145], v[144:145], v[42:43], v[40:41]
v_pk_fma_f32 v[146:147], v[146:147], v[42:43], v[40:41]
v_pk_mul_f32 v[144:145], v[144:145], v[52:53]
v_pk_mul_f32 v[146:147], v[146:147], v[54:55]
v_exp_f32 v144, v144
v_exp_f32 v145, v145
v_exp_f32 v146, v146
v_exp_f32 v147, v147
v_pk_add_f32 v[144:145], v[144:145], v[46:47]
v_pk_add_f32 v[146:147], v[146:147], v[46:47]
v_rcp_f32 v144, v144
v_rcp_f32 v145, v145
v_rcp_f32 v146, v146
v_rcp_f32 v147, v147
v_pk_mul_f32 v[52:53], v[52:53], v[144:145]
v_pk_mul_f32 v[54:55], v[54:55], v[146:147]
v_cvt_pk_bf16_f32 v154, v52, v53
v_cvt_pk_bf16_f32 v155, v54, v55
s_nop 0
v_permlane16_swap_b32 v152, v154
v_permlane16_swap_b32 v153, v155
s_cmp_eq_u32 s59, 1
s_cbranch_scc1 xs_31
buffer_store_dwordx4 v[152:155], v58, s[8:11], s41 offen offset:0 sc1
s_branch xs_32
xs_31:
buffer_store_dwordx4 v[152:155], v58, s[8:11], s41 offen offset:0
xs_32:
v_lshlrev_b32 v52, 16, v236
v_and_b32 v53, 0xffff0000, v236
v_lshlrev_b32 v54, 16, v237
v_and_b32 v55, 0xffff0000, v237
v_pk_fma_f32 v[52:53], v[38:39], v[16:17], v[52:53]
v_pk_fma_f32 v[54:55], v[38:39], v[18:19], v[54:55]
v_pk_fma_f32 v[52:53], v[36:37], v[212:213], v[52:53]
v_pk_fma_f32 v[54:55], v[36:37], v[214:215], v[54:55]
v_pk_mul_f32 v[144:145], v[52:53], v[52:53]
v_pk_mul_f32 v[146:147], v[54:55], v[54:55]
v_pk_fma_f32 v[144:145], v[144:145], v[42:43], v[40:41]
v_pk_fma_f32 v[146:147], v[146:147], v[42:43], v[40:41]
v_pk_mul_f32 v[144:145], v[144:145], v[52:53]
v_pk_mul_f32 v[146:147], v[146:147], v[54:55]
v_exp_f32 v144, v144
v_exp_f32 v145, v145
v_exp_f32 v146, v146
v_exp_f32 v147, v147
v_pk_add_f32 v[144:145], v[144:145], v[46:47]
v_pk_add_f32 v[146:147], v[146:147], v[46:47]
v_rcp_f32 v144, v144
v_rcp_f32 v145, v145
v_rcp_f32 v146, v146
v_rcp_f32 v147, v147
v_pk_mul_f32 v[52:53], v[52:53], v[144:145]
v_pk_mul_f32 v[54:55], v[54:55], v[146:147]
v_cvt_pk_bf16_f32 v156, v52, v53
v_cvt_pk_bf16_f32 v157, v54, v55
v_lshlrev_b32 v52, 16, v238
v_and_b32 v53, 0xffff0000, v238
v_lshlrev_b32 v54, 16, v239
v_and_b32 v55, 0xffff0000, v239
v_pk_fma_f32 v[52:53], v[38:39], v[20:21], v[52:53]
v_pk_fma_f32 v[54:55], v[38:39], v[22:23], v[54:55]
v_pk_fma_f32 v[52:53], v[36:37], v[216:217], v[52:53]
v_pk_fma_f32 v[54:55], v[36:37], v[218:219], v[54:55]
v_pk_mul_f32 v[144:145], v[52:53], v[52:53]
v_pk_mul_f32 v[146:147], v[54:55], v[54:55]
v_pk_fma_f32 v[144:145], v[144:145], v[42:43], v[40:41]
v_pk_fma_f32 v[146:147], v[146:147], v[42:43], v[40:41]
v_pk_mul_f32 v[144:145], v[144:145], v[52:53]
v_pk_mul_f32 v[146:147], v[146:147], v[54:55]
v_exp_f32 v144, v144
v_exp_f32 v145, v145
v_exp_f32 v146, v146
v_exp_f32 v147, v147
v_pk_add_f32 v[144:145], v[144:145], v[46:47]
v_pk_add_f32 v[146:147], v[146:147], v[46:47]
v_rcp_f32 v144, v144
v_rcp_f32 v145, v145
v_rcp_f32 v146, v146
v_rcp_f32 v147, v147
v_pk_mul_f32 v[52:53], v[52:53], v[144:145]
v_pk_mul_f32 v[54:55], v[54:55], v[146:147]
v_cvt_pk_bf16_f32 v158, v52, v53
v_cvt_pk_bf16_f32 v159, v54, v55
s_nop 0
v_permlane16_swap_b32 v156, v158
v_permlane16_swap_b32 v157, v159
s_cmp_eq_u32 s59, 1
s_cbranch_scc1 xs_33
buffer_store_dwordx4 v[156:159], v58, s[8:11], s41 offen offset:1024 sc1
s_branch xs_34
xs_33:
buffer_store_dwordx4 v[156:159], v58, s[8:11], s41 offen offset:1024
xs_34:
v_lshlrev_b32 v52, 16, v240
v_and_b32 v53, 0xffff0000, v240
v_lshlrev_b32 v54, 16, v241
v_and_b32 v55, 0xffff0000, v241
v_pk_fma_f32 v[52:53], v[38:39], v[24:25], v[52:53]
v_pk_fma_f32 v[54:55], v[38:39], v[26:27], v[54:55]
v_pk_fma_f32 v[52:53], v[36:37], v[220:221], v[52:53]
v_pk_fma_f32 v[54:55], v[36:37], v[222:223], v[54:55]
v_pk_mul_f32 v[144:145], v[52:53], v[52:53]
v_pk_mul_f32 v[146:147], v[54:55], v[54:55]
v_pk_fma_f32 v[144:145], v[144:145], v[42:43], v[40:41]
v_pk_fma_f32 v[146:147], v[146:147], v[42:43], v[40:41]
v_pk_mul_f32 v[144:145], v[144:145], v[52:53]
v_pk_mul_f32 v[146:147], v[146:147], v[54:55]
v_exp_f32 v144, v144
v_exp_f32 v145, v145
v_exp_f32 v146, v146
v_exp_f32 v147, v147
v_pk_add_f32 v[144:145], v[144:145], v[46:47]
v_pk_add_f32 v[146:147], v[146:147], v[46:47]
v_rcp_f32 v144, v144
v_rcp_f32 v145, v145
v_rcp_f32 v146, v146
v_rcp_f32 v147, v147
v_pk_mul_f32 v[52:53], v[52:53], v[144:145]
v_pk_mul_f32 v[54:55], v[54:55], v[146:147]
v_cvt_pk_bf16_f32 v152, v52, v53
v_cvt_pk_bf16_f32 v153, v54, v55
v_lshlrev_b32 v52, 16, v242
v_and_b32 v53, 0xffff0000, v242
v_lshlrev_b32 v54, 16, v243
v_and_b32 v55, 0xffff0000, v243
v_pk_fma_f32 v[52:53], v[38:39], v[28:29], v[52:53]
v_pk_fma_f32 v[54:55], v[38:39], v[30:31], v[54:55]
v_pk_fma_f32 v[52:53], v[36:37], v[224:225], v[52:53]
v_pk_fma_f32 v[54:55], v[36:37], v[226:227], v[54:55]
v_pk_mul_f32 v[144:145], v[52:53], v[52:53]
v_pk_mul_f32 v[146:147], v[54:55], v[54:55]
v_pk_fma_f32 v[144:145], v[144:145], v[42:43], v[40:41]
v_pk_fma_f32 v[146:147], v[146:147], v[42:43], v[40:41]
v_pk_mul_f32 v[144:145], v[144:145], v[52:53]
v_pk_mul_f32 v[146:147], v[146:147], v[54:55]
v_exp_f32 v144, v144
v_exp_f32 v145, v145
v_exp_f32 v146, v146
v_exp_f32 v147, v147
v_pk_add_f32 v[144:145], v[144:145], v[46:47]
v_pk_add_f32 v[146:147], v[146:147], v[46:47]
v_rcp_f32 v144, v144
v_rcp_f32 v145, v145
v_rcp_f32 v146, v146
v_rcp_f32 v147, v147
v_pk_mul_f32 v[52:53], v[52:53], v[144:145]
v_pk_mul_f32 v[54:55], v[54:55], v[146:147]
v_cvt_pk_bf16_f32 v154, v52, v53
v_cvt_pk_bf16_f32 v155, v54, v55
s_nop 0
v_permlane16_swap_b32 v152, v154
v_permlane16_swap_b32 v153, v155
s_cmp_eq_u32 s59, 1
s_cbranch_scc1 xs_35
buffer_store_dwordx4 v[152:155], v58, s[8:11], s41 offen offset:2048 sc1
s_branch xs_36
xs_35:
buffer_store_dwordx4 v[152:155], v58, s[8:11], s41 offen offset:2048
xs_36:
s_and_b32 s45, s36, s34
s_bitcmp1_b32 s45, 0
s_cbranch_scc1 fc1sk_37
v_lshlrev_b32 v52, 16, v244
v_and_b32 v53, 0xffff0000, v244
v_lshlrev_b32 v54, 16, v245
v_and_b32 v55, 0xffff0000, v245
v_pk_fma_f32 v[52:53], v[38:39], v[32:33], v[52:53]
v_pk_fma_f32 v[54:55], v[38:39], v[34:35], v[54:55]
v_pk_fma_f32 v[52:53], v[36:37], v[228:229], v[52:53]
v_pk_fma_f32 v[54:55], v[36:37], v[230:231], v[54:55]
v_pk_mul_f32 v[144:145], v[52:53], v[52:53]
v_pk_mul_f32 v[146:147], v[54:55], v[54:55]
v_pk_fma_f32 v[144:145], v[144:145], v[42:43], v[40:41]
v_pk_fma_f32 v[146:147], v[146:147], v[42:43], v[40:41]
v_pk_mul_f32 v[144:145], v[144:145], v[52:53]
v_pk_mul_f32 v[146:147], v[146:147], v[54:55]
v_exp_f32 v144, v144
v_exp_f32 v145, v145
v_exp_f32 v146, v146
v_exp_f32 v147, v147
v_pk_add_f32 v[144:145], v[144:145], v[46:47]
v_pk_add_f32 v[146:147], v[146:147], v[46:47]
v_rcp_f32 v144, v144
v_rcp_f32 v145, v145
v_rcp_f32 v146, v146
v_rcp_f32 v147, v147
v_pk_mul_f32 v[52:53], v[52:53], v[144:145]
v_pk_mul_f32 v[54:55], v[54:55], v[146:147]
v_cvt_pk_bf16_f32 v160, v52, v53
v_cvt_pk_bf16_f32 v161, v54, v55
s_cmp_eq_u32 s59, 1
s_cbranch_scc1 xs_38
buffer_store_dwordx2 v[160:161], v59, s[8:11], s41 offen offset:3072 sc1
s_branch xs_39
xs_38:
buffer_store_dwordx2 v[160:161], v59, s[8:11], s41 offen offset:3072
xs_39:
fc1sk_37:
s_lshl_b32 s46, s37, 13
s_lshl_b32 s45, s67, 6
s_add_u32 s46, s46, s45
s_add_u32 s46, s46, 6389760
s_lshl_b32 s47, s37, 13
s_lshl_b32 s45, s65, 6
s_add_u32 s47, s47, s45
s_add_u32 s47, s47, 6389760
s_lshl_b32 s45, s36, 3
s_and_b32 s44, s34, 1
s_lshl_b32 s44, s44, 2
s_add_u32 s45, s45, s44
s_add_u32 s46, s46, s45
s_add_u32 s47, s47, s45
s_waitcnt vmcnt(0)
v_mov_b32 v56, 0
v_mov_b32 v57, 1
s_mov_b64 s[42:43], exec
s_mov_b64 exec, 1
s_cmp_eq_u32 s59, 1
s_cbranch_scc1 sf_40
buffer_store_dword v57, v56, s[8:11], s46 offen sc1
buffer_store_dword v57, v56, s[8:11], s47 offen sc1
s_branch sf_41
sf_40:
buffer_store_dword v57, v56, s[8:11], s46 offen
buffer_store_dword v57, v56, s[8:11], s47 offen
sf_41:
s_mov_b64 exec, s[42:43]
s_mov_b32 s20, s26
s_mov_b32 s21, s27
s_mov_b32 s22, 1280
s_mov_b32 s23, 0x20000
v_lshlrev_b32 v58, 3, v4
s_mul_i32 s40, s36, 160
v_add_u32 v58, s40, v58
buffer_load_dwordx2 v[8:9], v58, s[20:23], 0 offen offset:0
buffer_load_dwordx2 v[10:11], v58, s[20:23], 0 offen offset:32
buffer_load_dwordx2 v[12:13], v58, s[20:23], 0 offen offset:64
buffer_load_dwordx2 v[14:15], v58, s[20:23], 0 offen offset:96
buffer_load_dwordx2 v[16:17], v58, s[20:23], 0 offen offset:128
s_and_b32 s45, s34, 1
s_mul_i32 s44, s45, 5120
v_add_u32 v6, s44, v5
v_add_u32 v7, 0x10000, v6
v_add_u32 v59, 114688, v6
s_xor_b32 s45, s45, 1
s_mul_i32 s44, s45, 109568
v_add_u32 v2, s44, v5
s_lshl_b32 s46, s37, 13
s_and_b32 s45, s67, -2
s_lshl_b32 s45, s45, 6
s_add_u32 s46, s46, s45
s_add_u32 s46, s46, 6389760
v_lshlrev_b32 v56, 2, v1
s_mov_b64 s[42:43], exec
s_mov_b64 exec, 0xffffffff
s_mov_b32 s44, 0
poll_42:
buffer_load_dword v57, v56, s[8:11], s46 offen sc1
s_add_u32 s44, s44, 1
s_waitcnt vmcnt(0)
v_cmp_eq_u32 vcc, 0, v57
s_nop 2
s_cmp_eq_u64 vcc, 0
s_cbranch_scc1 polld_43
s_cmp_gt_u32 s44, 200000
s_cbranch_scc1 polld_43
s_sleep 1
s_branch poll_42
polld_43:
s_mov_b64 exec, s[42:43]
s_mul_i32 s40, s67, 55296
s_mul_i32 s41, s65, 55296
s_mul_i32 s45, s37, 7077888
s_add_u32 s45, s45, 17444864
s_and_b32 s44, s34, 1
s_lshl_b32 s44, s44, 10
s_add_u32 s45, s45, s44
s_add_u32 s40, s40, s45
s_add_u32 s41, s41, s45
buffer_load_dwordx4 v[64:67], v5, s[8:11], s40 offen offset:0 sc1
buffer_load_dwordx4 v[68:71], v5, s[8:11], s41 offen offset:0 sc1
buffer_load_dwordx4 v[72:75], v5, s[8:11], s40 offen offset:2048 sc1
buffer_load_dwordx4 v[76:79], v5, s[8:11], s41 offen offset:2048 sc1
s_add_u32 s40, s40, 4096
s_add_u32 s41, s41, 4096
buffer_load_dwordx4 v[80:83], v5, s[8:11], s40 offen offset:0 sc1
buffer_load_dwordx4 v[84:87], v5, s[8:11], s41 offen offset:0 sc1
buffer_load_dwordx4 v[88:91], v5, s[8:11], s40 offen offset:2048 sc1
buffer_load_dwordx4 v[92:95], v5, s[8:11], s41 offen offset:2048 sc1
s_add_u32 s40, s40, 4096
s_add_u32 s41, s41, 4096
buffer_load_dwordx4 v[96:99], v5, s[8:11], s40 offen offset:0 sc1
buffer_load_dwordx4 v[100:103], v5, s[8:11], s41 offen offset:0 sc1
buffer_load_dwordx4 v[104:107], v5, s[8:11], s40 offen offset:2048 sc1
buffer_load_dwordx4 v[108:111], v5, s[8:11], s41 offen offset:2048 sc1
s_add_u32 s40, s40, 4096
s_add_u32 s41, s41, 4096
buffer_load_dwordx4 v[112:115], v5, s[8:11], s40 offen offset:0 sc1
buffer_load_dwordx4 v[116:119], v5, s[8:11], s41 offen offset:0 sc1
buffer_load_dwordx4 v[120:123], v5, s[8:11], s40 offen offset:2048 sc1
buffer_load_dwordx4 v[124:127], v5, s[8:11], s41 offen offset:2048 sc1
s_add_u32 s40, s40, 4096
s_add_u32 s41, s41, 4096
buffer_load_dwordx4 v[128:131], v5, s[8:11], s40 offen offset:0 sc1
buffer_load_dwordx4 v[132:135], v5, s[8:11], s41 offen offset:0 sc1
buffer_load_dwordx4 v[136:139], v5, s[8:11], s40 offen offset:2048 sc1
buffer_load_dwordx4 v[140:143], v5, s[8:11], s41 offen offset:2048 sc1
s_add_u32 s40, s40, 4096
s_add_u32 s41, s41, 4096
buffer_load_dwordx4 v[184:187], v5, s[8:11], s40 offen offset:0 sc1
buffer_load_dwordx4 v[188:191], v5, s[8:11], s41 offen offset:0 sc1
buffer_load_dwordx4 v[192:195], v5, s[8:11], s40 offen offset:2048 sc1
buffer_load_dwordx4 v[196:199], v5, s[8:11], s41 offen offset:2048 sc1
s_add_u32 s40, s40, 4096
s_add_u32 s41, s41, 4096
buffer_load_dwordx4 v[20:23], v5, s[8:11], s40 offen offset:0 sc1
buffer_load_dwordx4 v[24:27], v5, s[8:11], s41 offen offset:0 sc1
buffer_load_dwordx4 v[28:31], v5, s[8:11], s40 offen offset:2048 sc1
buffer_load_dwordx4 v[32:35], v5, s[8:11], s41 offen offset:2048 sc1
s_add_u32 s40, s40, 4096
s_add_u32 s41, s41, 4096
buffer_load_dwordx4 v[36:39], v5, s[8:11], s40 offen offset:0 sc1
buffer_load_dwordx4 v[40:43], v5, s[8:11], s41 offen offset:0 sc1
buffer_load_dwordx4 v[44:47], v5, s[8:11], s40 offen offset:2048 sc1
buffer_load_dwordx4 v[48:51], v5, s[8:11], s41 offen offset:2048 sc1
s_barrier
ds_read_b128 v[144:147], v6 offset:4096
ds_read_b128 v[148:151], v6 offset:5120
ds_read_b128 v[152:155], v6 offset:6144
ds_read_b128 v[156:159], v6 offset:7168
ds_read_b128 v[160:163], v6 offset:8192
s_waitcnt vmcnt(30)
s_waitcnt lgkmcnt(4)
v_mfma_f32_16x16x32_bf16 v[204:207], v[144:147], v[64:67], 0
s_mov_b32 s44, 117760
s_bitcmp1_b32 s34, 0
s_cselect_b32 s45, s44, 14336
v_add_u32 v58, s45, v5
ds_read_b128 v[164:167], v58
v_mfma_f32_16x16x32_bf16 v[224:227], v[144:147], v[68:71], 0
s_waitcnt lgkmcnt(4)
v_mfma_f32_16x16x32_bf16 v[208:211], v[148:151], v[64:67], 0
s_mov_b32 s44, 118784
s_bitcmp1_b32 s34, 0
s_cselect_b32 s45, s44, 15360
v_add_u32 v58, s45, v5
ds_read_b128 v[168:171], v58
v_mfma_f32_16x16x32_bf16 v[228:231], v[148:151], v[68:71], 0
s_waitcnt lgkmcnt(4)
v_mfma_f32_16x16x32_bf16 v[212:215], v[152:155], v[64:67], 0
ds_read_b128 v[172:175], v59 offset:0
v_mfma_f32_16x16x32_bf16 v[232:235], v[152:155], v[68:71], 0
s_waitcnt lgkmcnt(4)
v_mfma_f32_16x16x32_bf16 v[216:219], v[156:159], v[64:67], 0
ds_read_b128 v[176:179], v59 offset:1024
v_mfma_f32_16x16x32_bf16 v[236:239], v[156:159], v[68:71], 0
s_waitcnt lgkmcnt(4)
v_mfma_f32_16x16x32_bf16 v[220:223], v[160:163], v[64:67], 0
ds_read_b128 v[180:183], v59 offset:2048
v_mfma_f32_16x16x32_bf16 v[240:243], v[160:163], v[68:71], 0
s_add_u32 s40, s40, 4096
s_add_u32 s41, s41, 4096
buffer_load_dwordx4 v[64:67], v5, s[8:11], s40 offen offset:0 sc1
buffer_load_dwordx4 v[68:71], v5, s[8:11], s41 offen offset:0 sc1
s_barrier
s_waitcnt vmcnt(30)
s_waitcnt lgkmcnt(4)
v_mfma_f32_16x16x32_bf16 v[204:207], v[164:167], v[72:75], v[204:207]
ds_read_b128 v[144:147], v59 offset:8192
v_mfma_f32_16x16x32_bf16 v[224:227], v[164:167], v[76:79], v[224:227]
s_waitcnt lgkmcnt(4)
v_mfma_f32_16x16x32_bf16 v[208:211], v[168:171], v[72:75], v[208:211]
ds_read_b128 v[148:151], v59 offset:9216
v_mfma_f32_16x16x32_bf16 v[228:231], v[168:171], v[76:79], v[228:231]
s_waitcnt lgkmcnt(4)
v_mfma_f32_16x16x32_bf16 v[212:215], v[172:175], v[72:75], v[212:215]
ds_read_b128 v[152:155], v59 offset:10240
v_mfma_f32_16x16x32_bf16 v[232:235], v[172:175], v[76:79], v[232:235]
s_waitcnt lgkmcnt(4)
v_mfma_f32_16x16x32_bf16 v[216:219], v[176:179], v[72:75], v[216:219]
ds_read_b128 v[156:159], v59 offset:11264
v_mfma_f32_16x16x32_bf16 v[236:239], v[176:179], v[76:79], v[236:239]
s_waitcnt lgkmcnt(4)
v_mfma_f32_16x16x32_bf16 v[220:223], v[180:183], v[72:75], v[220:223]
ds_read_b128 v[160:163], v59 offset:12288
v_mfma_f32_16x16x32_bf16 v[240:243], v[180:183], v[76:79], v[240:243]
buffer_load_dwordx4 v[72:75], v5, s[8:11], s40 offen offset:2048 sc1
buffer_load_dwordx4 v[76:79], v5, s[8:11], s41 offen offset:2048 sc1
s_waitcnt vmcnt(30)
s_waitcnt lgkmcnt(4)
v_mfma_f32_16x16x32_bf16 v[204:207], v[144:147], v[80:83], v[204:207]
ds_read_b128 v[164:167], v59 offset:18432
v_mfma_f32_16x16x32_bf16 v[224:227], v[144:147], v[84:87], v[224:227]
s_waitcnt lgkmcnt(4)
v_mfma_f32_16x16x32_bf16 v[208:211], v[148:151], v[80:83], v[208:211]
ds_read_b128 v[168:171], v59 offset:19456
v_mfma_f32_16x16x32_bf16 v[228:231], v[148:151], v[84:87], v[228:231]
s_waitcnt lgkmcnt(4)
v_mfma_f32_16x16x32_bf16 v[212:215], v[152:155], v[80:83], v[212:215]
ds_read_b128 v[172:175], v59 offset:20480
v_mfma_f32_16x16x32_bf16 v[232:235], v[152:155], v[84:87], v[232:235]
s_waitcnt lgkmcnt(4)
v_mfma_f32_16x16x32_bf16 v[216:219], v[156:159], v[80:83], v[216:219]
ds_read_b128 v[176:179], v59 offset:21504
v_mfma_f32_16x16x32_bf16 v[236:239], v[156:159], v[84:87], v[236:239]
s_waitcnt lgkmcnt(4)
v_mfma_f32_16x16x32_bf16 v[220:223], v[160:163], v[80:83], v[220:223]
ds_read_b128 v[180:183], v59 offset:22528
v_mfma_f32_16x16x32_bf16 v[240:243], v[160:163], v[84:87], v[240:243]
s_add_u32 s40, s40, 4096
s_add_u32 s41, s41, 4096
buffer_load_dwordx4 v[80:83], v5, s[8:11], s40 offen offset:0 sc1
buffer_load_dwordx4 v[84:87], v5, s[8:11], s41 offen offset:0 sc1
s_barrier
s_waitcnt vmcnt(30)
s_waitcnt lgkmcnt(4)
v_mfma_f32_16x16x32_bf16 v[204:207], v[164:167], v[88:91], v[204:207]
ds_read_b128 v[144:147], v59 offset:28672
v_mfma_f32_16x16x32_bf16 v[224:227], v[164:167], v[92:95], v[224:227]
s_waitcnt lgkmcnt(4)
v_mfma_f32_16x16x32_bf16 v[208:211], v[168:171], v[88:91], v[208:211]
ds_read_b128 v[148:151], v59 offset:29696
v_mfma_f32_16x16x32_bf16 v[228:231], v[168:171], v[92:95], v[228:231]
s_waitcnt lgkmcnt(4)
v_mfma_f32_16x16x32_bf16 v[212:215], v[172:175], v[88:91], v[212:215]
ds_read_b128 v[152:155], v59 offset:30720
v_mfma_f32_16x16x32_bf16 v[232:235], v[172:175], v[92:95], v[232:235]
s_waitcnt lgkmcnt(4)
v_mfma_f32_16x16x32_bf16 v[216:219], v[176:179], v[88:91], v[216:219]
ds_read_b128 v[156:159], v59 offset:31744
v_mfma_f32_16x16x32_bf16 v[236:239], v[176:179], v[92:95], v[236:239]
s_waitcnt lgkmcnt(4)
v_mfma_f32_16x16x32_bf16 v[220:223], v[180:183], v[88:91], v[220:223]
ds_read_b128 v[160:163], v59 offset:32768
v_mfma_f32_16x16x32_bf16 v[240:243], v[180:183], v[92:95], v[240:243]
buffer_load_dwordx4 v[88:91], v5, s[8:11], s40 offen offset:2048 sc1
buffer_load_dwordx4 v[92:95], v5, s[8:11], s41 offen offset:2048 sc1
s_waitcnt vmcnt(30)
s_waitcnt lgkmcnt(4)
v_mfma_f32_16x16x32_bf16 v[204:207], v[144:147], v[96:99], v[204:207]
ds_read_b128 v[164:167], v59 offset:38912
v_mfma_f32_16x16x32_bf16 v[224:227], v[144:147], v[100:103], v[224:227]
s_waitcnt lgkmcnt(4)
v_mfma_f32_16x16x32_bf16 v[208:211], v[148:151], v[96:99], v[208:211]
ds_read_b128 v[168:171], v59 offset:39936
v_mfma_f32_16x16x32_bf16 v[228:231], v[148:151], v[100:103], v[228:231]
s_waitcnt lgkmcnt(4)
v_mfma_f32_16x16x32_bf16 v[212:215], v[152:155], v[96:99], v[212:215]
ds_read_b128 v[172:175], v59 offset:40960
v_mfma_f32_16x16x32_bf16 v[232:235], v[152:155], v[100:103], v[232:235]
s_waitcnt lgkmcnt(4)
v_mfma_f32_16x16x32_bf16 v[216:219], v[156:159], v[96:99], v[216:219]
ds_read_b128 v[176:179], v59 offset:41984
v_mfma_f32_16x16x32_bf16 v[236:239], v[156:159], v[100:103], v[236:239]
s_waitcnt lgkmcnt(4)
v_mfma_f32_16x16x32_bf16 v[220:223], v[160:163], v[96:99], v[220:223]
ds_read_b128 v[180:183], v59 offset:43008
v_mfma_f32_16x16x32_bf16 v[240:243], v[160:163], v[100:103], v[240:243]
s_add_u32 s40, s40, 4096
s_add_u32 s41, s41, 4096
buffer_load_dwordx4 v[96:99], v5, s[8:11], s40 offen offset:0 sc1
buffer_load_dwordx4 v[100:103], v5, s[8:11], s41 offen offset:0 sc1
s_barrier
s_waitcnt vmcnt(30)
s_waitcnt lgkmcnt(4)
v_mfma_f32_16x16x32_bf16 v[204:207], v[164:167], v[104:107], v[204:207]
ds_read_b128 v[144:147], v6 offset:16384
v_mfma_f32_16x16x32_bf16 v[224:227], v[164:167], v[108:111], v[224:227]
s_waitcnt lgkmcnt(4)
v_mfma_f32_16x16x32_bf16 v[208:211], v[168:171], v[104:107], v[208:211]
ds_read_b128 v[148:151], v6 offset:17408
v_mfma_f32_16x16x32_bf16 v[228:231], v[168:171], v[108:111], v[228:231]
s_waitcnt lgkmcnt(4)
v_mfma_f32_16x16x32_bf16 v[212:215], v[172:175], v[104:107], v[212:215]
ds_read_b128 v[152:155], v6 offset:18432
v_mfma_f32_16x16x32_bf16 v[232:235], v[172:175], v[108:111], v[232:235]
s_waitcnt lgkmcnt(4)
v_mfma_f32_16x16x32_bf16 v[216:219], v[176:179], v[104:107], v[216:219]
ds_read_b128 v[156:159], v6 offset:19456
v_mfma_f32_16x16x32_bf16 v[236:239], v[176:179], v[108:111], v[236:239]
s_waitcnt lgkmcnt(4)
v_mfma_f32_16x16x32_bf16 v[220:223], v[180:183], v[104:107], v[220:223]
ds_read_b128 v[160:163], v6 offset:20480
v_mfma_f32_16x16x32_bf16 v[240:243], v[180:183], v[108:111], v[240:243]
buffer_load_dwordx4 v[104:107], v5, s[8:11], s40 offen offset:2048 sc1
buffer_load_dwordx4 v[108:111], v5, s[8:11], s41 offen offset:2048 sc1
s_waitcnt vmcnt(30)
s_waitcnt lgkmcnt(4)
v_mfma_f32_16x16x32_bf16 v[204:207], v[144:147], v[112:115], v[204:207]
ds_read_b128 v[164:167], v6 offset:26624
v_mfma_f32_16x16x32_bf16 v[224:227], v[144:147], v[116:119], v[224:227]
s_waitcnt lgkmcnt(4)
v_mfma_f32_16x16x32_bf16 v[208:211], v[148:151], v[112:115], v[208:211]
ds_read_b128 v[168:171], v6 offset:27648
v_mfma_f32_16x16x32_bf16 v[228:231], v[148:151], v[116:119], v[228:231]
s_waitcnt lgkmcnt(4)
v_mfma_f32_16x16x32_bf16 v[212:215], v[152:155], v[112:115], v[212:215]
ds_read_b128 v[172:175], v6 offset:28672
v_mfma_f32_16x16x32_bf16 v[232:235], v[152:155], v[116:119], v[232:235]
s_waitcnt lgkmcnt(4)
v_mfma_f32_16x16x32_bf16 v[216:219], v[156:159], v[112:115], v[216:219]
ds_read_b128 v[176:179], v6 offset:29696
v_mfma_f32_16x16x32_bf16 v[236:239], v[156:159], v[116:119], v[236:239]
s_waitcnt lgkmcnt(4)
v_mfma_f32_16x16x32_bf16 v[220:223], v[160:163], v[112:115], v[220:223]
ds_read_b128 v[180:183], v6 offset:30720
v_mfma_f32_16x16x32_bf16 v[240:243], v[160:163], v[116:119], v[240:243]
s_add_u32 s40, s40, 4096
s_add_u32 s41, s41, 4096
buffer_load_dwordx4 v[112:115], v5, s[8:11], s40 offen offset:0 sc1
buffer_load_dwordx4 v[116:119], v5, s[8:11], s41 offen offset:0 sc1
s_barrier
s_waitcnt vmcnt(30)
s_waitcnt lgkmcnt(4)
v_mfma_f32_16x16x32_bf16 v[204:207], v[164:167], v[120:123], v[204:207]
ds_read_b128 v[144:147], v6 offset:36864
v_mfma_f32_16x16x32_bf16 v[224:227], v[164:167], v[124:127], v[224:227]
s_waitcnt lgkmcnt(4)
v_mfma_f32_16x16x32_bf16 v[208:211], v[168:171], v[120:123], v[208:211]
ds_read_b128 v[148:151], v6 offset:37888
v_mfma_f32_16x16x32_bf16 v[228:231], v[168:171], v[124:127], v[228:231]
s_waitcnt lgkmcnt(4)
v_mfma_f32_16x16x32_bf16 v[212:215], v[172:175], v[120:123], v[212:215]
ds_read_b128 v[152:155], v6 offset:38912
v_mfma_f32_16x16x32_bf16 v[232:235], v[172:175], v[124:127], v[232:235]
s_waitcnt lgkmcnt(4)
v_mfma_f32_16x16x32_bf16 v[216:219], v[176:179], v[120:123], v[216:219]
ds_read_b128 v[156:159], v6 offset:39936
v_mfma_f32_16x16x32_bf16 v[236:239], v[176:179], v[124:127], v[236:239]
s_waitcnt lgkmcnt(4)
v_mfma_f32_16x16x32_bf16 v[220:223], v[180:183], v[120:123], v[220:223]
ds_read_b128 v[160:163], v6 offset:40960
v_mfma_f32_16x16x32_bf16 v[240:243], v[180:183], v[124:127], v[240:243]
buffer_load_dwordx4 v[120:123], v5, s[8:11], s40 offen offset:2048 sc1
buffer_load_dwordx4 v[124:127], v5, s[8:11], s41 offen offset:2048 sc1
s_waitcnt vmcnt(30)
s_waitcnt lgkmcnt(4)
v_mfma_f32_16x16x32_bf16 v[204:207], v[144:147], v[128:131], v[204:207]
ds_read_b128 v[164:167], v6 offset:47104
v_mfma_f32_16x16x32_bf16 v[224:227], v[144:147], v[132:135], v[224:227]
s_waitcnt lgkmcnt(4)
v_mfma_f32_16x16x32_bf16 v[208:211], v[148:151], v[128:131], v[208:211]
ds_read_b128 v[168:171], v6 offset:48128
v_mfma_f32_16x16x32_bf16 v[228:231], v[148:151], v[132:135], v[228:231]
s_waitcnt lgkmcnt(4)
v_mfma_f32_16x16x32_bf16 v[212:215], v[152:155], v[128:131], v[212:215]
ds_read_b128 v[172:175], v6 offset:49152
v_mfma_f32_16x16x32_bf16 v[232:235], v[152:155], v[132:135], v[232:235]
s_waitcnt lgkmcnt(4)
v_mfma_f32_16x16x32_bf16 v[216:219], v[156:159], v[128:131], v[216:219]
ds_read_b128 v[176:179], v6 offset:50176
v_mfma_f32_16x16x32_bf16 v[236:239], v[156:159], v[132:135], v[236:239]
s_waitcnt lgkmcnt(4)
v_mfma_f32_16x16x32_bf16 v[220:223], v[160:163], v[128:131], v[220:223]
ds_read_b128 v[180:183], v6 offset:51200
v_mfma_f32_16x16x32_bf16 v[240:243], v[160:163], v[132:135], v[240:243]
s_add_u32 s40, s40, 4096
s_add_u32 s41, s41, 4096
buffer_load_dwordx4 v[128:131], v5, s[8:11], s40 offen offset:0 sc1
buffer_load_dwordx4 v[132:135], v5, s[8:11], s41 offen offset:0 sc1
s_barrier
s_waitcnt vmcnt(30)
s_waitcnt lgkmcnt(4)
v_mfma_f32_16x16x32_bf16 v[204:207], v[164:167], v[136:139], v[204:207]
ds_read_b128 v[144:147], v6 offset:57344
v_mfma_f32_16x16x32_bf16 v[224:227], v[164:167], v[140:143], v[224:227]
s_waitcnt lgkmcnt(4)
v_mfma_f32_16x16x32_bf16 v[208:211], v[168:171], v[136:139], v[208:211]
ds_read_b128 v[148:151], v6 offset:58368
v_mfma_f32_16x16x32_bf16 v[228:231], v[168:171], v[140:143], v[228:231]
s_waitcnt lgkmcnt(4)
v_mfma_f32_16x16x32_bf16 v[212:215], v[172:175], v[136:139], v[212:215]
ds_read_b128 v[152:155], v6 offset:59392
v_mfma_f32_16x16x32_bf16 v[232:235], v[172:175], v[140:143], v[232:235]
s_waitcnt lgkmcnt(4)
v_mfma_f32_16x16x32_bf16 v[216:219], v[176:179], v[136:139], v[216:219]
ds_read_b128 v[156:159], v6 offset:60416
v_mfma_f32_16x16x32_bf16 v[236:239], v[176:179], v[140:143], v[236:239]
s_waitcnt lgkmcnt(4)
v_mfma_f32_16x16x32_bf16 v[220:223], v[180:183], v[136:139], v[220:223]
ds_read_b128 v[160:163], v6 offset:61440
v_mfma_f32_16x16x32_bf16 v[240:243], v[180:183], v[140:143], v[240:243]
buffer_load_dwordx4 v[136:139], v5, s[8:11], s40 offen offset:2048 sc1
buffer_load_dwordx4 v[140:143], v5, s[8:11], s41 offen offset:2048 sc1
s_waitcnt vmcnt(30)
s_waitcnt lgkmcnt(4)
v_mfma_f32_16x16x32_bf16 v[204:207], v[144:147], v[184:187], v[204:207]
ds_read_b128 v[164:167], v7 offset:2048
v_mfma_f32_16x16x32_bf16 v[224:227], v[144:147], v[188:191], v[224:227]
s_waitcnt lgkmcnt(4)
v_mfma_f32_16x16x32_bf16 v[208:211], v[148:151], v[184:187], v[208:211]
ds_read_b128 v[168:171], v7 offset:3072
v_mfma_f32_16x16x32_bf16 v[228:231], v[148:151], v[188:191], v[228:231]
s_waitcnt lgkmcnt(4)
v_mfma_f32_16x16x32_bf16 v[212:215], v[152:155], v[184:187], v[212:215]
ds_read_b128 v[172:175], v7 offset:4096
v_mfma_f32_16x16x32_bf16 v[232:235], v[152:155], v[188:191], v[232:235]
s_waitcnt lgkmcnt(4)
v_mfma_f32_16x16x32_bf16 v[216:219], v[156:159], v[184:187], v[216:219]
ds_read_b128 v[176:179], v7 offset:5120
v_mfma_f32_16x16x32_bf16 v[236:239], v[156:159], v[188:191], v[236:239]
s_waitcnt lgkmcnt(4)
v_mfma_f32_16x16x32_bf16 v[220:223], v[160:163], v[184:187], v[220:223]
ds_read_b128 v[180:183], v7 offset:6144
v_mfma_f32_16x16x32_bf16 v[240:243], v[160:163], v[188:191], v[240:243]
s_add_u32 s40, s40, 4096
s_add_u32 s41, s41, 4096
buffer_load_dwordx4 v[184:187], v5, s[8:11], s40 offen offset:0 sc1
buffer_load_dwordx4 v[188:191], v5, s[8:11], s41 offen offset:0 sc1
s_barrier
s_waitcnt vmcnt(30)
s_waitcnt lgkmcnt(4)
v_mfma_f32_16x16x32_bf16 v[204:207], v[164:167], v[192:195], v[204:207]
ds_read_b128 v[144:147], v7 offset:12288
v_mfma_f32_16x16x32_bf16 v[224:227], v[164:167], v[196:199], v[224:227]
s_waitcnt lgkmcnt(4)
v_mfma_f32_16x16x32_bf16 v[208:211], v[168:171], v[192:195], v[208:211]
ds_read_b128 v[148:151], v7 offset:13312
v_mfma_f32_16x16x32_bf16 v[228:231], v[168:171], v[196:199], v[228:231]
s_waitcnt lgkmcnt(4)
v_mfma_f32_16x16x32_bf16 v[212:215], v[172:175], v[192:195], v[212:215]
ds_read_b128 v[152:155], v7 offset:14336
v_mfma_f32_16x16x32_bf16 v[232:235], v[172:175], v[196:199], v[232:235]
s_waitcnt lgkmcnt(4)
v_mfma_f32_16x16x32_bf16 v[216:219], v[176:179], v[192:195], v[216:219]
ds_read_b128 v[156:159], v7 offset:15360
v_mfma_f32_16x16x32_bf16 v[236:239], v[176:179], v[196:199], v[236:239]
s_waitcnt lgkmcnt(4)
v_mfma_f32_16x16x32_bf16 v[220:223], v[180:183], v[192:195], v[220:223]
ds_read_b128 v[160:163], v7 offset:16384
v_mfma_f32_16x16x32_bf16 v[240:243], v[180:183], v[196:199], v[240:243]
s_waitcnt vmcnt(28)
s_waitcnt lgkmcnt(4)
v_mfma_f32_16x16x32_bf16 v[204:207], v[144:147], v[20:23], v[204:207]
ds_read_b128 v[164:167], v7 offset:22528
v_mfma_f32_16x16x32_bf16 v[224:227], v[144:147], v[24:27], v[224:227]
s_waitcnt lgkmcnt(4)
v_mfma_f32_16x16x32_bf16 v[208:211], v[148:151], v[20:23], v[208:211]
ds_read_b128 v[168:171], v7 offset:23552
v_mfma_f32_16x16x32_bf16 v[228:231], v[148:151], v[24:27], v[228:231]
s_waitcnt lgkmcnt(4)
v_mfma_f32_16x16x32_bf16 v[212:215], v[152:155], v[20:23], v[212:215]
ds_read_b128 v[172:175], v7 offset:24576
v_mfma_f32_16x16x32_bf16 v[232:235], v[152:155], v[24:27], v[232:235]
s_waitcnt lgkmcnt(4)
v_mfma_f32_16x16x32_bf16 v[216:219], v[156:159], v[20:23], v[216:219]
ds_read_b128 v[176:179], v7 offset:25600
v_mfma_f32_16x16x32_bf16 v[236:239], v[156:159], v[24:27], v[236:239]
s_waitcnt lgkmcnt(4)
v_mfma_f32_16x16x32_bf16 v[220:223], v[160:163], v[20:23], v[220:223]
ds_read_b128 v[180:183], v7 offset:26624
v_mfma_f32_16x16x32_bf16 v[240:243], v[160:163], v[24:27], v[240:243]
s_barrier
s_waitcnt vmcnt(26)
s_waitcnt lgkmcnt(4)
v_mfma_f32_16x16x32_bf16 v[204:207], v[164:167], v[28:31], v[204:207]
ds_read_b128 v[144:147], v7 offset:32768
v_mfma_f32_16x16x32_bf16 v[224:227], v[164:167], v[32:35], v[224:227]
s_waitcnt lgkmcnt(4)
v_mfma_f32_16x16x32_bf16 v[208:211], v[168:171], v[28:31], v[208:211]
ds_read_b128 v[148:151], v7 offset:33792
v_mfma_f32_16x16x32_bf16 v[228:231], v[168:171], v[32:35], v[228:231]
s_waitcnt lgkmcnt(4)
v_mfma_f32_16x16x32_bf16 v[212:215], v[172:175], v[28:31], v[212:215]
ds_read_b128 v[152:155], v7 offset:34816
v_mfma_f32_16x16x32_bf16 v[232:235], v[172:175], v[32:35], v[232:235]
s_waitcnt lgkmcnt(4)
v_mfma_f32_16x16x32_bf16 v[216:219], v[176:179], v[28:31], v[216:219]
ds_read_b128 v[156:159], v7 offset:35840
v_mfma_f32_16x16x32_bf16 v[236:239], v[176:179], v[32:35], v[236:239]
s_waitcnt lgkmcnt(4)
v_mfma_f32_16x16x32_bf16 v[220:223], v[180:183], v[28:31], v[220:223]
ds_read_b128 v[160:163], v7 offset:36864
v_mfma_f32_16x16x32_bf16 v[240:243], v[180:183], v[32:35], v[240:243]
s_waitcnt vmcnt(24)
s_waitcnt lgkmcnt(4)
v_mfma_f32_16x16x32_bf16 v[204:207], v[144:147], v[36:39], v[204:207]
ds_read_b128 v[164:167], v7 offset:43008
v_mfma_f32_16x16x32_bf16 v[224:227], v[144:147], v[40:43], v[224:227]
s_waitcnt lgkmcnt(4)
v_mfma_f32_16x16x32_bf16 v[208:211], v[148:151], v[36:39], v[208:211]
ds_read_b128 v[168:171], v2 offset:0
v_mfma_f32_16x16x32_bf16 v[228:231], v[148:151], v[40:43], v[228:231]
s_waitcnt lgkmcnt(4)
v_mfma_f32_16x16x32_bf16 v[212:215], v[152:155], v[36:39], v[212:215]
ds_read_b128 v[172:175], v2 offset:1024
v_mfma_f32_16x16x32_bf16 v[232:235], v[152:155], v[40:43], v[232:235]
s_waitcnt lgkmcnt(4)
v_mfma_f32_16x16x32_bf16 v[216:219], v[156:159], v[36:39], v[216:219]
ds_read_b128 v[176:179], v2 offset:2048
v_mfma_f32_16x16x32_bf16 v[236:239], v[156:159], v[40:43], v[236:239]
s_waitcnt lgkmcnt(4)
v_mfma_f32_16x16x32_bf16 v[220:223], v[160:163], v[36:39], v[220:223]
ds_read_b128 v[180:183], v2 offset:3072
v_mfma_f32_16x16x32_bf16 v[240:243], v[160:163], v[40:43], v[240:243]
s_barrier
s_waitcnt vmcnt(22)
s_waitcnt lgkmcnt(4)
v_mfma_f32_16x16x32_bf16 v[204:207], v[164:167], v[44:47], v[204:207]
ds_read_b128 v[144:147], v6 offset:4096
v_mfma_f32_16x16x32_bf16 v[224:227], v[164:167], v[48:51], v[224:227]
s_waitcnt lgkmcnt(4)
v_mfma_f32_16x16x32_bf16 v[208:211], v[168:171], v[44:47], v[208:211]
ds_read_b128 v[148:151], v6 offset:5120
v_mfma_f32_16x16x32_bf16 v[228:231], v[168:171], v[48:51], v[228:231]
s_waitcnt lgkmcnt(4)
v_mfma_f32_16x16x32_bf16 v[212:215], v[172:175], v[44:47], v[212:215]
ds_read_b128 v[152:155], v6 offset:6144
v_mfma_f32_16x16x32_bf16 v[232:235], v[172:175], v[48:51], v[232:235]
s_waitcnt lgkmcnt(4)
v_mfma_f32_16x16x32_bf16 v[216:219], v[176:179], v[44:47], v[216:219]
ds_read_b128 v[156:159], v6 offset:7168
v_mfma_f32_16x16x32_bf16 v[236:239], v[176:179], v[48:51], v[236:239]
s_waitcnt lgkmcnt(4)
v_mfma_f32_16x16x32_bf16 v[220:223], v[180:183], v[44:47], v[220:223]
ds_read_b128 v[160:163], v6 offset:8192
v_mfma_f32_16x16x32_bf16 v[240:243], v[180:183], v[48:51], v[240:243]
s_waitcnt vmcnt(20)
s_waitcnt lgkmcnt(4)
v_mfma_f32_16x16x32_bf16 v[204:207], v[144:147], v[64:67], v[204:207]
ds_read_b128 v[164:167], v6 offset:14336
v_mfma_f32_16x16x32_bf16 v[224:227], v[144:147], v[68:71], v[224:227]
s_waitcnt lgkmcnt(4)
v_mfma_f32_16x16x32_bf16 v[208:211], v[148:151], v[64:67], v[208:211]
ds_read_b128 v[168:171], v6 offset:15360
v_mfma_f32_16x16x32_bf16 v[228:231], v[148:151], v[68:71], v[228:231]
s_waitcnt lgkmcnt(4)
v_mfma_f32_16x16x32_bf16 v[212:215], v[152:155], v[64:67], v[212:215]
ds_read_b128 v[172:175], v6 offset:16384
v_mfma_f32_16x16x32_bf16 v[232:235], v[152:155], v[68:71], v[232:235]
s_waitcnt lgkmcnt(4)
v_mfma_f32_16x16x32_bf16 v[216:219], v[156:159], v[64:67], v[216:219]
ds_read_b128 v[176:179], v6 offset:17408
v_mfma_f32_16x16x32_bf16 v[236:239], v[156:159], v[68:71], v[236:239]
s_waitcnt lgkmcnt(4)
v_mfma_f32_16x16x32_bf16 v[220:223], v[160:163], v[64:67], v[220:223]
ds_read_b128 v[180:183], v6 offset:18432
v_mfma_f32_16x16x32_bf16 v[240:243], v[160:163], v[68:71], v[240:243]
s_barrier
s_waitcnt vmcnt(18)
s_waitcnt lgkmcnt(4)
v_mfma_f32_16x16x32_bf16 v[204:207], v[164:167], v[72:75], v[204:207]
ds_read_b128 v[144:147], v6 offset:24576
v_mfma_f32_16x16x32_bf16 v[224:227], v[164:167], v[76:79], v[224:227]
s_waitcnt lgkmcnt(4)
v_mfma_f32_16x16x32_bf16 v[208:211], v[168:171], v[72:75], v[208:211]
ds_read_b128 v[148:151], v6 offset:25600
v_mfma_f32_16x16x32_bf16 v[228:231], v[168:171], v[76:79], v[228:231]
s_waitcnt lgkmcnt(4)
v_mfma_f32_16x16x32_bf16 v[212:215], v[172:175], v[72:75], v[212:215]
ds_read_b128 v[152:155], v6 offset:26624
v_mfma_f32_16x16x32_bf16 v[232:235], v[172:175], v[76:79], v[232:235]
s_waitcnt lgkmcnt(4)
v_mfma_f32_16x16x32_bf16 v[216:219], v[176:179], v[72:75], v[216:219]
ds_read_b128 v[156:159], v6 offset:27648
v_mfma_f32_16x16x32_bf16 v[236:239], v[176:179], v[76:79], v[236:239]
s_waitcnt lgkmcnt(4)
v_mfma_f32_16x16x32_bf16 v[220:223], v[180:183], v[72:75], v[220:223]
ds_read_b128 v[160:163], v6 offset:28672
v_mfma_f32_16x16x32_bf16 v[240:243], v[180:183], v[76:79], v[240:243]
s_waitcnt vmcnt(16)
s_waitcnt lgkmcnt(4)
v_mfma_f32_16x16x32_bf16 v[204:207], v[144:147], v[80:83], v[204:207]
ds_read_b128 v[164:167], v6 offset:34816
v_mfma_f32_16x16x32_bf16 v[224:227], v[144:147], v[84:87], v[224:227]
s_waitcnt lgkmcnt(4)
v_mfma_f32_16x16x32_bf16 v[208:211], v[148:151], v[80:83], v[208:211]
ds_read_b128 v[168:171], v6 offset:35840
v_mfma_f32_16x16x32_bf16 v[228:231], v[148:151], v[84:87], v[228:231]
s_waitcnt lgkmcnt(4)
v_mfma_f32_16x16x32_bf16 v[212:215], v[152:155], v[80:83], v[212:215]
ds_read_b128 v[172:175], v6 offset:36864
v_mfma_f32_16x16x32_bf16 v[232:235], v[152:155], v[84:87], v[232:235]
s_waitcnt lgkmcnt(4)
v_mfma_f32_16x16x32_bf16 v[216:219], v[156:159], v[80:83], v[216:219]
ds_read_b128 v[176:179], v6 offset:37888
v_mfma_f32_16x16x32_bf16 v[236:239], v[156:159], v[84:87], v[236:239]
s_waitcnt lgkmcnt(4)
v_mfma_f32_16x16x32_bf16 v[220:223], v[160:163], v[80:83], v[220:223]
ds_read_b128 v[180:183], v6 offset:38912
v_mfma_f32_16x16x32_bf16 v[240:243], v[160:163], v[84:87], v[240:243]
s_barrier
s_waitcnt vmcnt(14)
s_waitcnt lgkmcnt(4)
v_mfma_f32_16x16x32_bf16 v[204:207], v[164:167], v[88:91], v[204:207]
ds_read_b128 v[144:147], v6 offset:45056
v_mfma_f32_16x16x32_bf16 v[224:227], v[164:167], v[92:95], v[224:227]
s_waitcnt lgkmcnt(4)
v_mfma_f32_16x16x32_bf16 v[208:211], v[168:171], v[88:91], v[208:211]
ds_read_b128 v[148:151], v6 offset:46080
v_mfma_f32_16x16x32_bf16 v[228:231], v[168:171], v[92:95], v[228:231]
s_waitcnt lgkmcnt(4)
v_mfma_f32_16x16x32_bf16 v[212:215], v[172:175], v[88:91], v[212:215]
ds_read_b128 v[152:155], v6 offset:47104
v_mfma_f32_16x16x32_bf16 v[232:235], v[172:175], v[92:95], v[232:235]
s_waitcnt lgkmcnt(4)
v_mfma_f32_16x16x32_bf16 v[216:219], v[176:179], v[88:91], v[216:219]
ds_read_b128 v[156:159], v6 offset:48128
v_mfma_f32_16x16x32_bf16 v[236:239], v[176:179], v[92:95], v[236:239]
s_waitcnt lgkmcnt(4)
v_mfma_f32_16x16x32_bf16 v[220:223], v[180:183], v[88:91], v[220:223]
ds_read_b128 v[160:163], v6 offset:49152
v_mfma_f32_16x16x32_bf16 v[240:243], v[180:183], v[92:95], v[240:243]
s_waitcnt vmcnt(12)
s_waitcnt lgkmcnt(4)
v_mfma_f32_16x16x32_bf16 v[204:207], v[144:147], v[96:99], v[204:207]
ds_read_b128 v[164:167], v6 offset:55296
v_mfma_f32_16x16x32_bf16 v[224:227], v[144:147], v[100:103], v[224:227]
s_waitcnt lgkmcnt(4)
v_mfma_f32_16x16x32_bf16 v[208:211], v[148:151], v[96:99], v[208:211]
ds_read_b128 v[168:171], v6 offset:56320
v_mfma_f32_16x16x32_bf16 v[228:231], v[148:151], v[100:103], v[228:231]
s_waitcnt lgkmcnt(4)
v_mfma_f32_16x16x32_bf16 v[212:215], v[152:155], v[96:99], v[212:215]
ds_read_b128 v[172:175], v6 offset:57344
v_mfma_f32_16x16x32_bf16 v[232:235], v[152:155], v[100:103], v[232:235]
s_waitcnt lgkmcnt(4)
v_mfma_f32_16x16x32_bf16 v[216:219], v[156:159], v[96:99], v[216:219]
ds_read_b128 v[176:179], v6 offset:58368
v_mfma_f32_16x16x32_bf16 v[236:239], v[156:159], v[100:103], v[236:239]
s_waitcnt lgkmcnt(4)
v_mfma_f32_16x16x32_bf16 v[220:223], v[160:163], v[96:99], v[220:223]
ds_read_b128 v[180:183], v6 offset:59392
v_mfma_f32_16x16x32_bf16 v[240:243], v[160:163], v[100:103], v[240:243]
s_barrier
s_waitcnt vmcnt(10)
s_waitcnt lgkmcnt(4)
v_mfma_f32_16x16x32_bf16 v[204:207], v[164:167], v[104:107], v[204:207]
ds_read_b128 v[144:147], v7 offset:0
v_mfma_f32_16x16x32_bf16 v[224:227], v[164:167], v[108:111], v[224:227]
s_waitcnt lgkmcnt(4)
v_mfma_f32_16x16x32_bf16 v[208:211], v[168:171], v[104:107], v[208:211]
ds_read_b128 v[148:151], v7 offset:1024
v_mfma_f32_16x16x32_bf16 v[228:231], v[168:171], v[108:111], v[228:231]
s_waitcnt lgkmcnt(4)
v_mfma_f32_16x16x32_bf16 v[212:215], v[172:175], v[104:107], v[212:215]
ds_read_b128 v[152:155], v7 offset:2048
v_mfma_f32_16x16x32_bf16 v[232:235], v[172:175], v[108:111], v[232:235]
s_waitcnt lgkmcnt(4)
v_mfma_f32_16x16x32_bf16 v[216:219], v[176:179], v[104:107], v[216:219]
ds_read_b128 v[156:159], v7 offset:3072
v_mfma_f32_16x16x32_bf16 v[236:239], v[176:179], v[108:111], v[236:239]
s_waitcnt lgkmcnt(4)
v_mfma_f32_16x16x32_bf16 v[220:223], v[180:183], v[104:107], v[220:223]
ds_read_b128 v[160:163], v7 offset:4096
v_mfma_f32_16x16x32_bf16 v[240:243], v[180:183], v[108:111], v[240:243]
s_waitcnt vmcnt(8)
s_waitcnt lgkmcnt(4)
v_mfma_f32_16x16x32_bf16 v[204:207], v[144:147], v[112:115], v[204:207]
ds_read_b128 v[164:167], v7 offset:10240
v_mfma_f32_16x16x32_bf16 v[224:227], v[144:147], v[116:119], v[224:227]
s_waitcnt lgkmcnt(4)
v_mfma_f32_16x16x32_bf16 v[208:211], v[148:151], v[112:115], v[208:211]
ds_read_b128 v[168:171], v7 offset:11264
v_mfma_f32_16x16x32_bf16 v[228:231], v[148:151], v[116:119], v[228:231]
s_waitcnt lgkmcnt(4)
v_mfma_f32_16x16x32_bf16 v[212:215], v[152:155], v[112:115], v[212:215]
ds_read_b128 v[172:175], v7 offset:12288
v_mfma_f32_16x16x32_bf16 v[232:235], v[152:155], v[116:119], v[232:235]
s_waitcnt lgkmcnt(4)
v_mfma_f32_16x16x32_bf16 v[216:219], v[156:159], v[112:115], v[216:219]
ds_read_b128 v[176:179], v7 offset:13312
v_mfma_f32_16x16x32_bf16 v[236:239], v[156:159], v[116:119], v[236:239]
s_waitcnt lgkmcnt(4)
v_mfma_f32_16x16x32_bf16 v[220:223], v[160:163], v[112:115], v[220:223]
ds_read_b128 v[180:183], v7 offset:14336
v_mfma_f32_16x16x32_bf16 v[240:243], v[160:163], v[116:119], v[240:243]
s_barrier
s_waitcnt vmcnt(6)
s_waitcnt lgkmcnt(4)
v_mfma_f32_16x16x32_bf16 v[204:207], v[164:167], v[120:123], v[204:207]
ds_read_b128 v[144:147], v7 offset:20480
v_mfma_f32_16x16x32_bf16 v[224:227], v[164:167], v[124:127], v[224:227]
s_waitcnt lgkmcnt(4)
v_mfma_f32_16x16x32_bf16 v[208:211], v[168:171], v[120:123], v[208:211]
ds_read_b128 v[148:151], v7 offset:21504
v_mfma_f32_16x16x32_bf16 v[228:231], v[168:171], v[124:127], v[228:231]
s_waitcnt lgkmcnt(4)
v_mfma_f32_16x16x32_bf16 v[212:215], v[172:175], v[120:123], v[212:215]
ds_read_b128 v[152:155], v7 offset:22528
v_mfma_f32_16x16x32_bf16 v[232:235], v[172:175], v[124:127], v[232:235]
s_waitcnt lgkmcnt(4)
v_mfma_f32_16x16x32_bf16 v[216:219], v[176:179], v[120:123], v[216:219]
ds_read_b128 v[156:159], v7 offset:23552
v_mfma_f32_16x16x32_bf16 v[236:239], v[176:179], v[124:127], v[236:239]
s_waitcnt lgkmcnt(4)
v_mfma_f32_16x16x32_bf16 v[220:223], v[180:183], v[120:123], v[220:223]
ds_read_b128 v[160:163], v7 offset:24576
v_mfma_f32_16x16x32_bf16 v[240:243], v[180:183], v[124:127], v[240:243]
s_waitcnt vmcnt(4)
s_waitcnt lgkmcnt(4)
v_mfma_f32_16x16x32_bf16 v[204:207], v[144:147], v[128:131], v[204:207]
ds_read_b128 v[164:167], v7 offset:30720
v_mfma_f32_16x16x32_bf16 v[224:227], v[144:147], v[132:135], v[224:227]
s_waitcnt lgkmcnt(4)
v_mfma_f32_16x16x32_bf16 v[208:211], v[148:151], v[128:131], v[208:211]
ds_read_b128 v[168:171], v7 offset:31744
v_mfma_f32_16x16x32_bf16 v[228:231], v[148:151], v[132:135], v[228:231]
s_waitcnt lgkmcnt(4)
v_mfma_f32_16x16x32_bf16 v[212:215], v[152:155], v[128:131], v[212:215]
ds_read_b128 v[172:175], v7 offset:32768
v_mfma_f32_16x16x32_bf16 v[232:235], v[152:155], v[132:135], v[232:235]
s_waitcnt lgkmcnt(4)
v_mfma_f32_16x16x32_bf16 v[216:219], v[156:159], v[128:131], v[216:219]
ds_read_b128 v[176:179], v7 offset:33792
v_mfma_f32_16x16x32_bf16 v[236:239], v[156:159], v[132:135], v[236:239]
s_waitcnt lgkmcnt(4)
v_mfma_f32_16x16x32_bf16 v[220:223], v[160:163], v[128:131], v[220:223]
ds_read_b128 v[180:183], v7 offset:34816
v_mfma_f32_16x16x32_bf16 v[240:243], v[160:163], v[132:135], v[240:243]
s_barrier
s_waitcnt vmcnt(2)
s_waitcnt lgkmcnt(4)
v_mfma_f32_16x16x32_bf16 v[204:207], v[164:167], v[136:139], v[204:207]
ds_read_b128 v[144:147], v7 offset:40960
v_mfma_f32_16x16x32_bf16 v[224:227], v[164:167], v[140:143], v[224:227]
s_waitcnt lgkmcnt(4)
v_mfma_f32_16x16x32_bf16 v[208:211], v[168:171], v[136:139], v[208:211]
ds_read_b128 v[148:151], v7 offset:41984
v_mfma_f32_16x16x32_bf16 v[228:231], v[168:171], v[140:143], v[228:231]
s_waitcnt lgkmcnt(4)
v_mfma_f32_16x16x32_bf16 v[212:215], v[172:175], v[136:139], v[212:215]
ds_read_b128 v[152:155], v7 offset:43008
v_mfma_f32_16x16x32_bf16 v[232:235], v[172:175], v[140:143], v[232:235]
s_waitcnt lgkmcnt(4)
v_mfma_f32_16x16x32_bf16 v[216:219], v[176:179], v[136:139], v[216:219]
ds_read_b128 v[156:159], v2 offset:0
v_mfma_f32_16x16x32_bf16 v[236:239], v[176:179], v[140:143], v[236:239]
s_waitcnt lgkmcnt(4)
v_mfma_f32_16x16x32_bf16 v[220:223], v[180:183], v[136:139], v[220:223]
ds_read_b128 v[160:163], v2 offset:1024
v_mfma_f32_16x16x32_bf16 v[240:243], v[180:183], v[140:143], v[240:243]
s_waitcnt vmcnt(0)
s_waitcnt lgkmcnt(4)
v_mfma_f32_16x16x32_bf16 v[204:207], v[144:147], v[184:187], v[204:207]
v_mfma_f32_16x16x32_bf16 v[224:227], v[144:147], v[188:191], v[224:227]
s_waitcnt lgkmcnt(3)
v_mfma_f32_16x16x32_bf16 v[208:211], v[148:151], v[184:187], v[208:211]
v_mfma_f32_16x16x32_bf16 v[228:231], v[148:151], v[188:191], v[228:231]
s_waitcnt lgkmcnt(2)
v_mfma_f32_16x16x32_bf16 v[212:215], v[152:155], v[184:187], v[212:215]
v_mfma_f32_16x16x32_bf16 v[232:235], v[152:155], v[188:191], v[232:235]
s_waitcnt lgkmcnt(1)
v_mfma_f32_16x16x32_bf16 v[216:219], v[156:159], v[184:187], v[216:219]
v_mfma_f32_16x16x32_bf16 v[236:239], v[156:159], v[188:191], v[236:239]
s_waitcnt lgkmcnt(0)
v_mfma_f32_16x16x32_bf16 v[220:223], v[160:163], v[184:187], v[220:223]
v_mfma_f32_16x16x32_bf16 v[240:243], v[160:163], v[188:191], v[240:243]
s_and_b32 s45, s34, 3
s_lshl_b32 s44, s45, 13
s_add_u32 s44, s44, 114688
v_add_u32 v56, s44, v5
ds_write_b128 v56, v[224:227] offset:0
ds_write_b128 v56, v[228:231] offset:1024
ds_write_b128 v56, v[232:235] offset:2048
ds_write_b128 v56, v[236:239] offset:3072
ds_write_b128 v56, v[240:243] offset:4096
s_xor_b32 s45, s45, 1
s_lshl_b32 s44, s45, 13
s_add_u32 s44, s44, 114688
v_add_u32 v57, s44, v5
s_waitcnt lgkmcnt(0)
s_barrier
ds_read_b128 v[144:147], v57 offset:0
ds_read_b128 v[148:151], v57 offset:1024
ds_read_b128 v[152:155], v57 offset:2048
ds_read_b128 v[156:159], v57 offset:3072
ds_read_b128 v[160:163], v57 offset:4096
s_waitcnt lgkmcnt(0)
v_add_f32 v204, v204, v144
v_add_f32 v205, v205, v145
v_add_f32 v206, v206, v146
v_add_f32 v207, v207, v147
v_add_f32 v208, v208, v148
v_add_f32 v209, v209, v149
v_add_f32 v210, v210, v150
v_add_f32 v211, v211, v151
v_add_f32 v212, v212, v152
v_add_f32 v213, v213, v153
v_add_f32 v214, v214, v154
v_add_f32 v215, v215, v155
v_add_f32 v216, v216, v156
v_add_f32 v217, v217, v157
v_add_f32 v218, v218, v158
v_add_f32 v219, v219, v159
v_add_f32 v220, v220, v160
v_add_f32 v221, v221, v161
v_add_f32 v222, v222, v162
v_add_f32 v223, v223, v163
v_lshlrev_b32 v48, 16, v246
v_and_b32 v49, 0xffff0000, v246
v_lshlrev_b32 v50, 16, v247
v_and_b32 v51, 0xffff0000, v247
v_lshlrev_b32 v52, 16, v8
v_and_b32 v53, 0xffff0000, v8
v_lshlrev_b32 v54, 16, v9
v_and_b32 v55, 0xffff0000, v9
v_add_f32 v52, v52, v204
v_add_f32 v53, v53, v205
v_add_f32 v54, v54, v206
v_add_f32 v55, v55, v207
v_add_f32 v48, v48, v52
v_add_f32 v49, v49, v53
v_add_f32 v50, v50, v54
v_add_f32 v51, v51, v55
v_cvt_pk_bf16_f32 v246, v48, v49
v_cvt_pk_bf16_f32 v247, v50, v51
v_lshlrev_b32 v48, 16, v248
v_and_b32 v49, 0xffff0000, v248
v_lshlrev_b32 v50, 16, v249
v_and_b32 v51, 0xffff0000, v249
v_lshlrev_b32 v52, 16, v10
v_and_b32 v53, 0xffff0000, v10
v_lshlrev_b32 v54, 16, v11
v_and_b32 v55, 0xffff0000, v11
v_add_f32 v52, v52, v208
v_add_f32 v53, v53, v209
v_add_f32 v54, v54, v210
v_add_f32 v55, v55, v211
v_add_f32 v48, v48, v52
v_add_f32 v49, v49, v53
v_add_f32 v50, v50, v54
v_add_f32 v51, v51, v55
v_cvt_pk_bf16_f32 v248, v48, v49
v_cvt_pk_bf16_f32 v249, v50, v51
v_lshlrev_b32 v48, 16, v250
v_and_b32 v49, 0xffff0000, v250
v_lshlrev_b32 v50, 16, v251
v_and_b32 v51, 0xffff0000, v251
v_lshlrev_b32 v52, 16, v12
v_and_b32 v53, 0xffff0000, v12
v_lshlrev_b32 v54, 16, v13
v_and_b32 v55, 0xffff0000, v13
v_add_f32 v52, v52, v212
v_add_f32 v53, v53, v213
v_add_f32 v54, v54, v214
v_add_f32 v55, v55, v215
v_add_f32 v48, v48, v52
v_add_f32 v49, v49, v53
v_add_f32 v50, v50, v54
v_add_f32 v51, v51, v55
v_cvt_pk_bf16_f32 v250, v48, v49
v_cvt_pk_bf16_f32 v251, v50, v51
v_lshlrev_b32 v48, 16, v252
v_and_b32 v49, 0xffff0000, v252
v_lshlrev_b32 v50, 16, v253
v_and_b32 v51, 0xffff0000, v253
v_lshlrev_b32 v52, 16, v14
v_and_b32 v53, 0xffff0000, v14
v_lshlrev_b32 v54, 16, v15
v_and_b32 v55, 0xffff0000, v15
v_add_f32 v52, v52, v216
v_add_f32 v53, v53, v217
v_add_f32 v54, v54, v218
v_add_f32 v55, v55, v219
v_add_f32 v48, v48, v52
v_add_f32 v49, v49, v53
v_add_f32 v50, v50, v54
v_add_f32 v51, v51, v55
v_cvt_pk_bf16_f32 v252, v48, v49
v_cvt_pk_bf16_f32 v253, v50, v51
v_lshlrev_b32 v48, 16, v254
v_and_b32 v49, 0xffff0000, v254
v_lshlrev_b32 v50, 16, v255
v_and_b32 v51, 0xffff0000, v255
v_lshlrev_b32 v52, 16, v16
v_and_b32 v53, 0xffff0000, v16
v_lshlrev_b32 v54, 16, v17
v_and_b32 v55, 0xffff0000, v17
v_add_f32 v52, v52, v220
v_add_f32 v53, v53, v221
v_add_f32 v54, v54, v222
v_add_f32 v55, v55, v223
v_add_f32 v48, v48, v52
v_add_f32 v49, v49, v53
v_add_f32 v50, v50, v54
v_add_f32 v51, v51, v55
v_cvt_pk_bf16_f32 v254, v48, v49
v_cvt_pk_bf16_f32 v255, v50, v51
s_cmp_eq_u32 s37, 0
s_cbranch_scc0 fc2_last
v_lshrrev_b32 v61, 1, v4
v_lshlrev_b32 v61, 8, v61
v_lshl_add_u32 v61, v3, 4, v61
s_lshl_b32 s45, s68, 9
v_add_u32 v61, s45, v61
v_and_b32 v62, 1, v4
v_lshl_add_u32 v60, v62, 9, v61
v_lshl_add_u32 v61, v62, 3, v61
s_mul_i32 s40, s67, 20480
s_mul_i32 s41, s65, 20480
s_mov_b32 s45, 31600640
s_add_u32 s40, s40, s45
s_add_u32 s41, s41, s45
v_mov_b32 v48, v246
v_mov_b32 v49, v247
v_mov_b32 v50, v248
v_mov_b32 v51, v249
s_nop 0
v_permlane16_swap_b32 v48, v50
v_permlane16_swap_b32 v49, v51
v_mov_b32 v52, v250
v_mov_b32 v53, v251
v_mov_b32 v54, v252
v_mov_b32 v55, v253
s_nop 0
v_permlane16_swap_b32 v52, v54
v_permlane16_swap_b32 v53, v55
s_cmp_eq_u32 s59, 1
s_cbranch_scc1 xs_45
buffer_store_dwordx4 v[48:51], v60, s[8:11], s40 offen offset:0 sc1
buffer_store_dwordx4 v[52:55], v60, s[8:11], s40 offen offset:1024 sc1
buffer_store_dwordx2 v[254:255], v61, s[8:11], s40 offen offset:2048 sc1
s_branch xs_46
xs_45:
buffer_store_dwordx4 v[48:51], v60, s[8:11], s40 offen offset:0
buffer_store_dwordx4 v[52:55], v60, s[8:11], s40 offen offset:1024
buffer_store_dwordx2 v[254:255], v61, s[8:11], s40 offen offset:2048
xs_46:
s_lshl_b32 s46, s37, 13
s_lshl_b32 s45, s67, 6
s_add_u32 s46, s46, s45
s_add_u32 s46, s46, 6406144
s_lshl_b32 s45, s36, 2
s_add_u32 s46, s46, s45
s_waitcnt vmcnt(0)
v_mov_b32 v56, 0
v_mov_b32 v57, 1
s_mov_b64 s[42:43], exec
s_mov_b64 exec, 1
s_cmp_eq_u32 s59, 1
s_cbranch_scc1 sf_47
buffer_store_dword v57, v56, s[8:11], s46 offen sc1
s_branch sf_48
sf_47:
buffer_store_dword v57, v56, s[8:11], s46 offen
sf_48:
s_mov_b64 exec, s[42:43]
s_branch fc2_fin
fc2_last:
s_mov_b32 s16, s28
s_mov_b32 s17, s29
s_mov_b32 s18, 2621440
s_mov_b32 s19, 0x20000
v_add_u32 v62, s66, v3
v_mul_u32_u24 v60, 1280, v62
s_mul_i32 s40, s36, 160
v_add_u32 v60, s40, v60
v_lshl_add_u32 v61, v4, 3, v60
v_and_b32 v62, 1, v4
v_lshl_add_u32 v60, v62, 5, v60
v_lshrrev_b32 v62, 1, v4
v_lshl_add_u32 v60, v62, 4, v60
v_mov_b32 v48, v246
v_mov_b32 v49, v247
v_mov_b32 v50, v248
v_mov_b32 v51, v249
s_nop 0
v_permlane16_swap_b32 v48, v50
v_permlane16_swap_b32 v49, v51
v_mov_b32 v52, v250
v_mov_b32 v53, v251
v_mov_b32 v54, v252
v_mov_b32 v55, v253
s_nop 0
v_permlane16_swap_b32 v52, v54
v_permlane16_swap_b32 v53, v55
buffer_store_dwordx4 v[48:51], v60, s[16:19], 0 offen offset:0
buffer_store_dwordx4 v[52:55], v60, s[16:19], 0 offen offset:64
buffer_store_dwordx2 v[254:255], v61, s[16:19], 0 offen offset:128
fc2_fin:
s_branch layer_end
ld_qkv:
s_cmp_eq_u32 s37, 0
s_cbranch_scc0 ld_qkv1
s_waitcnt vmcnt(0)
s_barrier
s_add_u32 m0, s69, 32768
s_add_u32 s44, s60, 32768
buffer_load_dwordx4 v5, s[8:11], s44 offen offset:0 lds
buffer_load_dwordx4 v5, s[8:11], s44 offen offset:1024 lds
buffer_load_dwordx4 v5, s[8:11], s44 offen offset:2048 lds
buffer_load_dwordx4 v5, s[8:11], s44 offen offset:3072 lds
s_add_u32 m0, s69, 49152
s_add_u32 s44, s60, 49152
buffer_load_dwordx4 v5, s[8:11], s44 offen offset:0 lds
buffer_load_dwordx4 v5, s[8:11], s44 offen offset:1024 lds
buffer_load_dwordx4 v5, s[8:11], s44 offen offset:2048 lds
buffer_load_dwordx4 v5, s[8:11], s44 offen offset:3072 lds
s_add_u32 m0, s69, 65536
s_add_u32 s44, s60, 65536
buffer_load_dwordx4 v5, s[8:11], s44 offen offset:0 lds
buffer_load_dwordx4 v5, s[8:11], s44 offen offset:1024 lds
buffer_load_dwordx4 v5, s[8:11], s44 offen offset:2048 lds
buffer_load_dwordx4 v5, s[8:11], s44 offen offset:3072 lds
s_add_u32 m0, s69, 81920
s_add_u32 s44, s60, 81920
buffer_load_dwordx4 v5, s[8:11], s44 offen offset:0 lds
buffer_load_dwordx4 v5, s[8:11], s44 offen offset:1024 lds
buffer_load_dwordx4 v5, s[8:11], s44 offen offset:2048 lds
buffer_load_dwordx4 v5, s[8:11], s44 offen offset:3072 lds
s_add_u32 m0, s69, 98304
s_add_u32 s44, s60, 98304
buffer_load_dwordx4 v5, s[8:11], s44 offen offset:0 lds
buffer_load_dwordx4 v5, s[8:11], s44 offen offset:1024 lds
buffer_load_dwordx4 v5, s[8:11], s44 offen offset:2048 lds
buffer_load_dwordx4 v5, s[8:11], s44 offen offset:3072 lds
s_branch ld_qkv2
ld_qkv1:
s_waitcnt vmcnt(20)
s_barrier
ld_qkv2:
s_barrier
s_waitcnt vmcnt(16)
s_barrier
s_add_u32 m0, s69, 0
s_add_u32 s44, s60, 114688
buffer_load_dwordx4 v5, s[8:11], s44 offen offset:0 lds
buffer_load_dwordx4 v5, s[8:11], s44 offen offset:1024 lds
buffer_load_dwordx4 v5, s[8:11], s44 offen offset:2048 lds
buffer_load_dwordx4 v5, s[8:11], s44 offen offset:3072 lds
s_waitcnt vmcnt(16)
s_barrier
s_waitcnt vmcnt(12)
s_barrier
s_add_u32 m0, s69, 16384
s_add_u32 s44, s60, 131072
buffer_load_dwordx4 v5, s[8:11], s44 offen offset:0 lds
buffer_load_dwordx4 v5, s[8:11], s44 offen offset:1024 lds
buffer_load_dwordx4 v5, s[8:11], s44 offen offset:2048 lds
buffer_load_dwordx4 v5, s[8:11], s44 offen offset:3072 lds
s_add_u32 m0, s69, 32768
s_add_u32 s44, s60, 147456
buffer_load_dwordx4 v5, s[8:11], s44 offen offset:0 lds
buffer_load_dwordx4 v5, s[8:11], s44 offen offset:1024 lds
buffer_load_dwordx4 v5, s[8:11], s44 offen offset:2048 lds
buffer_load_dwordx4 v5, s[8:11], s44 offen offset:3072 lds
s_waitcnt vmcnt(12)
s_barrier
s_add_u32 m0, s69, 49152
s_add_u32 s44, s60, 163840
buffer_load_dwordx4 v5, s[8:11], s44 offen offset:0 lds
buffer_load_dwordx4 v5, s[8:11], s44 offen offset:1024 lds
buffer_load_dwordx4 v5, s[8:11], s44 offen offset:2048 lds
buffer_load_dwordx4 v5, s[8:11], s44 offen offset:3072 lds
s_waitcnt vmcnt(12)
s_barrier
s_add_u32 m0, s69, 65536
s_add_u32 s44, s60, 180224
buffer_load_dwordx4 v5, s[8:11], s44 offen offset:0 lds
buffer_load_dwordx4 v5, s[8:11], s44 offen offset:1024 lds
buffer_load_dwordx4 v5, s[8:11], s44 offen offset:2048 lds
buffer_load_dwordx4 v5, s[8:11], s44 offen offset:3072 lds
s_barrier
s_barrier
s_add_u32 m0, s69, 81920
s_add_u32 s44, s60, 196608
buffer_load_dwordx4 v5, s[8:11], s44 offen offset:0 lds
buffer_load_dwordx4 v5, s[8:11], s44 offen offset:1024 lds
buffer_load_dwordx4 v5, s[8:11], s44 offen offset:2048 lds
buffer_load_dwordx4 v5, s[8:11], s44 offen offset:3072 lds
s_add_u32 m0, s69, 98304
s_add_u32 s44, s60, 212992
buffer_load_dwordx4 v5, s[8:11], s44 offen offset:0 lds
buffer_load_dwordx4 v5, s[8:11], s44 offen offset:1024 lds
buffer_load_dwordx4 v5, s[8:11], s44 offen offset:2048 lds
buffer_load_dwordx4 v5, s[8:11], s44 offen offset:3072 lds
s_branch att_top
ld_wo:
s_barrier
s_barrier
s_add_u32 m0, s69, 0
s_add_u32 s44, s60, 278528
buffer_load_dwordx4 v5, s[8:11], s44 offen offset:0 lds
buffer_load_dwordx4 v5, s[8:11], s44 offen offset:1024 lds
buffer_load_dwordx4 v5, s[8:11], s44 offen offset:2048 lds
buffer_load_dwordx4 v5, s[8:11], s44 offen offset:3072 lds
s_add_u32 m0, s69, 16384
s_add_u32 s44, s60, 294912
buffer_load_dwordx4 v5, s[8:11], s44 offen offset:0 lds
buffer_load_dwordx4 v5, s[8:11], s44 offen offset:1024 lds
buffer_load_dwordx4 v5, s[8:11], s44 offen offset:2048 lds
buffer_load_dwordx4 v5, s[8:11], s44 offen offset:3072 lds
s_add_u32 m0, s69, 32768
s_add_u32 s44, s60, 311296
buffer_load_dwordx4 v5, s[8:11], s44 offen offset:0 lds
buffer_load_dwordx4 v5, s[8:11], s44 offen offset:1024 lds
buffer_load_dwordx4 v5, s[8:11], s44 offen offset:2048 lds
buffer_load_dwordx4 v5, s[8:11], s44 offen offset:3072 lds
s_barrier
s_barrier
s_add_u32 m0, s69, 114688
s_add_u32 s44, s60, 229376
buffer_load_dwordx4 v5, s[8:11], s44 offen offset:0 lds
buffer_load_dwordx4 v5, s[8:11], s44 offen offset:1024 lds
buffer_load_dwordx4 v5, s[8:11], s44 offen offset:2048 lds
buffer_load_dwordx4 v5, s[8:11], s44 offen offset:3072 lds
s_add_u32 m0, s69, 131072
s_add_u32 s44, s60, 245760
buffer_load_dwordx4 v5, s[8:11], s44 offen offset:0 lds
buffer_load_dwordx4 v5, s[8:11], s44 offen offset:1024 lds
buffer_load_dwordx4 v5, s[8:11], s44 offen offset:2048 lds
buffer_load_dwordx4 v5, s[8:11], s44 offen offset:3072 lds
s_add_u32 m0, s69, 147456
s_add_u32 s44, s60, 262144
buffer_load_dwordx4 v5, s[8:11], s44 offen offset:0 lds
buffer_load_dwordx4 v5, s[8:11], s44 offen offset:1024 lds
buffer_load_dwordx4 v5, s[8:11], s44 offen offset:2048 lds
buffer_load_dwordx4 v5, s[8:11], s44 offen offset:3072 lds
s_add_u32 m0, s69, 49152
s_add_u32 s44, s60, 327680
buffer_load_dwordx4 v5, s[8:11], s44 offen offset:0 lds
buffer_load_dwordx4 v5, s[8:11], s44 offen offset:1024 lds
buffer_load_dwordx4 v5, s[8:11], s44 offen offset:2048 lds
buffer_load_dwordx4 v5, s[8:11], s44 offen offset:3072 lds
s_add_u32 m0, s69, 65536
s_add_u32 s44, s60, 344064
buffer_load_dwordx4 v5, s[8:11], s44 offen offset:0 lds
buffer_load_dwordx4 v5, s[8:11], s44 offen offset:1024 lds
buffer_load_dwordx4 v5, s[8:11], s44 offen offset:2048 lds
buffer_load_dwordx4 v5, s[8:11], s44 offen offset:3072 lds
s_add_u32 m0, s69, 81920
s_add_u32 s44, s60, 360448
buffer_load_dwordx4 v5, s[8:11], s44 offen offset:0 lds
buffer_load_dwordx4 v5, s[8:11], s44 offen offset:1024 lds
buffer_load_dwordx4 v5, s[8:11], s44 offen offset:2048 lds
buffer_load_dwordx4 v5, s[8:11], s44 offen offset:3072 lds
ld_fc1:
s_waitcnt vmcnt(16)
s_barrier
s_waitcnt vmcnt(12)
s_barrier
s_add_u32 m0, s69, 98304
s_add_u32 s44, s60, 376832
buffer_load_dwordx4 v5, s[8:11], s44 offen offset:0 lds
buffer_load_dwordx4 v5, s[8:11], s44 offen offset:1024 lds
buffer_load_dwordx4 v5, s[8:11], s44 offen offset:2048 lds
buffer_load_dwordx4 v5, s[8:11], s44 offen offset:3072 lds
s_barrier
s_waitcnt vmcnt(12)
s_barrier
s_add_u32 m0, s69, 0
s_add_u32 s44, s60, 393216
buffer_load_dwordx4 v5, s[8:11], s44 offen offset:0 lds
buffer_load_dwordx4 v5, s[8:11], s44 offen offset:1024 lds
buffer_load_dwordx4 v5, s[8:11], s44 offen offset:2048 lds
buffer_load_dwordx4 v5, s[8:11], s44 offen offset:3072 lds
s_waitcnt vmcnt(8)
s_barrier
s_add_u32 m0, s69, 16384
s_add_u32 s44, s60, 409600
buffer_load_dwordx4 v5, s[8:11], s44 offen offset:0 lds
buffer_load_dwordx4 v5, s[8:11], s44 offen offset:1024 lds
buffer_load_dwordx4 v5, s[8:11], s44 offen offset:2048 lds
buffer_load_dwordx4 v5, s[8:11], s44 offen offset:3072 lds
s_waitcnt vmcnt(4)
s_barrier
s_add_u32 m0, s69, 32768
s_add_u32 s44, s60, 425984
buffer_load_dwordx4 v5, s[8:11], s44 offen offset:0 lds
buffer_load_dwordx4 v5, s[8:11], s44 offen offset:1024 lds
buffer_load_dwordx4 v5, s[8:11], s44 offen offset:2048 lds
buffer_load_dwordx4 v5, s[8:11], s44 offen offset:3072 lds
s_add_u32 m0, s69, 49152
s_add_u32 s44, s60, 442368
buffer_load_dwordx4 v5, s[8:11], s44 offen offset:0 lds
buffer_load_dwordx4 v5, s[8:11], s44 offen offset:1024 lds
buffer_load_dwordx4 v5, s[8:11], s44 offen offset:2048 lds
buffer_load_dwordx4 v5, s[8:11], s44 offen offset:3072 lds
s_waitcnt vmcnt(8)
s_barrier
s_add_u32 m0, s69, 65536
s_add_u32 s44, s60, 458752
buffer_load_dwordx4 v5, s[8:11], s44 offen offset:0 lds
buffer_load_dwordx4 v5, s[8:11], s44 offen offset:1024 lds
buffer_load_dwordx4 v5, s[8:11], s44 offen offset:2048 lds
buffer_load_dwordx4 v5, s[8:11], s44 offen offset:3072 lds
s_add_u32 m0, s69, 81920
s_add_u32 s44, s60, 475136
buffer_load_dwordx4 v5, s[8:11], s44 offen offset:0 lds
buffer_load_dwordx4 v5, s[8:11], s44 offen offset:1024 lds
buffer_load_dwordx4 v5, s[8:11], s44 offen offset:2048 lds
buffer_load_dwordx4 v5, s[8:11], s44 offen offset:3072 lds
s_waitcnt vmcnt(8)
s_barrier
s_add_u32 m0, s69, 98304
s_add_u32 s44, s60, 491520
buffer_load_dwordx4 v5, s[8:11], s44 offen offset:0 lds
buffer_load_dwordx4 v5, s[8:11], s44 offen offset:1024 lds
buffer_load_dwordx4 v5, s[8:11], s44 offen offset:2048 lds
buffer_load_dwordx4 v5, s[8:11], s44 offen offset:3072 lds
s_add_u32 m0, s69, 0
s_add_u32 s44, s60, 507904
buffer_load_dwordx4 v5, s[8:11], s44 offen offset:0 lds
buffer_load_dwordx4 v5, s[8:11], s44 offen offset:1024 lds
buffer_load_dwordx4 v5, s[8:11], s44 offen offset:2048 lds
buffer_load_dwordx4 v5, s[8:11], s44 offen offset:3072 lds
s_waitcnt vmcnt(8)
s_barrier
s_add_u32 m0, s69, 16384
s_add_u32 s44, s60, 573440
buffer_load_dwordx4 v5, s[8:11], s44 offen offset:0 lds
buffer_load_dwordx4 v5, s[8:11], s44 offen offset:1024 lds
buffer_load_dwordx4 v5, s[8:11], s44 offen offset:2048 lds
buffer_load_dwordx4 v5, s[8:11], s44 offen offset:3072 lds
s_waitcnt vmcnt(4)
s_barrier
s_add_u32 m0, s69, 32768
s_add_u32 s44, s60, 589824
buffer_load_dwordx4 v5, s[8:11], s44 offen offset:0 lds
buffer_load_dwordx4 v5, s[8:11], s44 offen offset:1024 lds
buffer_load_dwordx4 v5, s[8:11], s44 offen offset:2048 lds
buffer_load_dwordx4 v5, s[8:11], s44 offen offset:3072 lds
s_add_u32 m0, s69, 49152
s_add_u32 s44, s60, 606208
buffer_load_dwordx4 v5, s[8:11], s44 offen offset:0 lds
buffer_load_dwordx4 v5, s[8:11], s44 offen offset:1024 lds
buffer_load_dwordx4 v5, s[8:11], s44 offen offset:2048 lds
buffer_load_dwordx4 v5, s[8:11], s44 offen offset:3072 lds
s_barrier
s_barrier
s_add_u32 m0, s69, 114688
s_add_u32 s44, s60, 524288
buffer_load_dwordx4 v5, s[8:11], s44 offen offset:0 lds
buffer_load_dwordx4 v5, s[8:11], s44 offen offset:1024 lds
buffer_load_dwordx4 v5, s[8:11], s44 offen offset:2048 lds
buffer_load_dwordx4 v5, s[8:11], s44 offen offset:3072 lds
s_add_u32 m0, s69, 131072
s_add_u32 s44, s60, 540672
buffer_load_dwordx4 v5, s[8:11], s44 offen offset:0 lds
buffer_load_dwordx4 v5, s[8:11], s44 offen offset:1024 lds
buffer_load_dwordx4 v5, s[8:11], s44 offen offset:2048 lds
buffer_load_dwordx4 v5, s[8:11], s44 offen offset:3072 lds
s_add_u32 m0, s69, 147456
s_add_u32 s44, s60, 557056
buffer_load_dwordx4 v5, s[8:11], s44 offen offset:0 lds
buffer_load_dwordx4 v5, s[8:11], s44 offen offset:1024 lds
buffer_load_dwordx4 v5, s[8:11], s44 offen offset:2048 lds
buffer_load_dwordx4 v5, s[8:11], s44 offen offset:3072 lds
s_add_u32 m0, s69, 65536
s_add_u32 s44, s60, 622592
buffer_load_dwordx4 v5, s[8:11], s44 offen offset:0 lds
buffer_load_dwordx4 v5, s[8:11], s44 offen offset:1024 lds
buffer_load_dwordx4 v5, s[8:11], s44 offen offset:2048 lds
buffer_load_dwordx4 v5, s[8:11], s44 offen offset:3072 lds
s_add_u32 m0, s69, 81920
s_add_u32 s44, s60, 638976
buffer_load_dwordx4 v5, s[8:11], s44 offen offset:0 lds
buffer_load_dwordx4 v5, s[8:11], s44 offen offset:1024 lds
buffer_load_dwordx4 v5, s[8:11], s44 offen offset:2048 lds
buffer_load_dwordx4 v5, s[8:11], s44 offen offset:3072 lds
s_add_u32 m0, s69, 98304
s_add_u32 s44, s60, 655360
buffer_load_dwordx4 v5, s[8:11], s44 offen offset:0 lds
buffer_load_dwordx4 v5, s[8:11], s44 offen offset:1024 lds
buffer_load_dwordx4 v5, s[8:11], s44 offen offset:2048 lds
buffer_load_dwordx4 v5, s[8:11], s44 offen offset:3072 lds
ld_fc2:
s_waitcnt vmcnt(20)
s_barrier
s_waitcnt vmcnt(16)
s_barrier
s_waitcnt vmcnt(12)
s_barrier
s_add_u32 m0, s69, 0
s_add_u32 s44, s60, 671744
buffer_load_dwordx4 v5, s[8:11], s44 offen offset:0 lds
buffer_load_dwordx4 v5, s[8:11], s44 offen offset:1024 lds
buffer_load_dwordx4 v5, s[8:11], s44 offen offset:2048 lds
buffer_load_dwordx4 v5, s[8:11], s44 offen offset:3072 lds
s_barrier
s_barrier
s_waitcnt vmcnt(12)
s_barrier
s_add_u32 m0, s69, 16384
s_add_u32 s44, s60, 688128
buffer_load_dwordx4 v5, s[8:11], s44 offen offset:0 lds
buffer_load_dwordx4 v5, s[8:11], s44 offen offset:1024 lds
buffer_load_dwordx4 v5, s[8:11], s44 offen offset:2048 lds
buffer_load_dwordx4 v5, s[8:11], s44 offen offset:3072 lds
s_waitcnt vmcnt(12)
s_barrier
s_add_u32 m0, s69, 32768
s_add_u32 s44, s60, 704512
buffer_load_dwordx4 v5, s[8:11], s44 offen offset:0 lds
buffer_load_dwordx4 v5, s[8:11], s44 offen offset:1024 lds
buffer_load_dwordx4 v5, s[8:11], s44 offen offset:2048 lds
buffer_load_dwordx4 v5, s[8:11], s44 offen offset:3072 lds
s_add_u32 m0, s69, 49152
s_add_u32 s44, s60, 720896
buffer_load_dwordx4 v5, s[8:11], s44 offen offset:0 lds
buffer_load_dwordx4 v5, s[8:11], s44 offen offset:1024 lds
buffer_load_dwordx4 v5, s[8:11], s44 offen offset:2048 lds
buffer_load_dwordx4 v5, s[8:11], s44 offen offset:3072 lds
s_waitcnt vmcnt(12)
s_barrier
s_add_u32 m0, s69, 65536
s_add_u32 s44, s60, 737280
buffer_load_dwordx4 v5, s[8:11], s44 offen offset:0 lds
buffer_load_dwordx4 v5, s[8:11], s44 offen offset:1024 lds
buffer_load_dwordx4 v5, s[8:11], s44 offen offset:2048 lds
buffer_load_dwordx4 v5, s[8:11], s44 offen offset:3072 lds
s_waitcnt vmcnt(12)
s_barrier
s_add_u32 m0, s69, 81920
s_add_u32 s44, s60, 753664
buffer_load_dwordx4 v5, s[8:11], s44 offen offset:0 lds
buffer_load_dwordx4 v5, s[8:11], s44 offen offset:1024 lds
buffer_load_dwordx4 v5, s[8:11], s44 offen offset:2048 lds
buffer_load_dwordx4 v5, s[8:11], s44 offen offset:3072 lds
s_waitcnt vmcnt(12)
s_barrier
s_add_u32 m0, s69, 98304
s_add_u32 s44, s60, 770048
buffer_load_dwordx4 v5, s[8:11], s44 offen offset:0 lds
buffer_load_dwordx4 v5, s[8:11], s44 offen offset:1024 lds
buffer_load_dwordx4 v5, s[8:11], s44 offen offset:2048 lds
buffer_load_dwordx4 v5, s[8:11], s44 offen offset:3072 lds
s_waitcnt vmcnt(12)
s_barrier
s_add_u32 m0, s69, 0
s_add_u32 s44, s60, 786432
buffer_load_dwordx4 v5, s[8:11], s44 offen offset:0 lds
buffer_load_dwordx4 v5, s[8:11], s44 offen offset:1024 lds
buffer_load_dwordx4 v5, s[8:11], s44 offen offset:2048 lds
buffer_load_dwordx4 v5, s[8:11], s44 offen offset:3072 lds
s_waitcnt vmcnt(8)
s_barrier
s_waitcnt vmcnt(4)
s_barrier
s_waitcnt vmcnt(0)
s_barrier
s_barrier
s_cmp_eq_u32 s37, 1
s_cbranch_scc1 ldsk_44
s_add_u32 m0, s69, 0
s_add_u32 s44, s60, 0
buffer_load_dwordx4 v5, s[8:11], s44 offen offset:0 lds
buffer_load_dwordx4 v5, s[8:11], s44 offen offset:1024 lds
buffer_load_dwordx4 v5, s[8:11], s44 offen offset:2048 lds
buffer_load_dwordx4 v5, s[8:11], s44 offen offset:3072 lds
s_add_u32 m0, s69, 16384
s_add_u32 s44, s60, 16384
buffer_load_dwordx4 v5, s[8:11], s44 offen offset:0 lds
buffer_load_dwordx4 v5, s[8:11], s44 offen offset:1024 lds
buffer_load_dwordx4 v5, s[8:11], s44 offen offset:2048 lds
buffer_load_dwordx4 v5, s[8:11], s44 offen offset:3072 lds
s_add_u32 m0, s69, 32768
s_add_u32 s44, s60, 32768
buffer_load_dwordx4 v5, s[8:11], s44 offen offset:0 lds
buffer_load_dwordx4 v5, s[8:11], s44 offen offset:1024 lds
buffer_load_dwordx4 v5, s[8:11], s44 offen offset:2048 lds
buffer_load_dwordx4 v5, s[8:11], s44 offen offset:3072 lds
s_add_u32 m0, s69, 49152
s_add_u32 s44, s60, 49152
buffer_load_dwordx4 v5, s[8:11], s44 offen offset:0 lds
buffer_load_dwordx4 v5, s[8:11], s44 offen offset:1024 lds
buffer_load_dwordx4 v5, s[8:11], s44 offen offset:2048 lds
buffer_load_dwordx4 v5, s[8:11], s44 offen offset:3072 lds
s_add_u32 m0, s69, 65536
s_add_u32 s44, s60, 65536
buffer_load_dwordx4 v5, s[8:11], s44 offen offset:0 lds
buffer_load_dwordx4 v5, s[8:11], s44 offen offset:1024 lds
buffer_load_dwordx4 v5, s[8:11], s44 offen offset:2048 lds
buffer_load_dwordx4 v5, s[8:11], s44 offen offset:3072 lds
s_add_u32 m0, s69, 81920
s_add_u32 s44, s60, 81920
buffer_load_dwordx4 v5, s[8:11], s44 offen offset:0 lds
buffer_load_dwordx4 v5, s[8:11], s44 offen offset:1024 lds
buffer_load_dwordx4 v5, s[8:11], s44 offen offset:2048 lds
buffer_load_dwordx4 v5, s[8:11], s44 offen offset:3072 lds
s_add_u32 m0, s69, 98304
s_add_u32 s44, s60, 98304
buffer_load_dwordx4 v5, s[8:11], s44 offen offset:0 lds
buffer_load_dwordx4 v5, s[8:11], s44 offen offset:1024 lds
buffer_load_dwordx4 v5, s[8:11], s44 offen offset:2048 lds
buffer_load_dwordx4 v5, s[8:11], s44 offen offset:3072 lds
ldsk_44:
s_branch layer_end
att_fallback:
s_barrier
v_mov_b32 v181, 0xff800000
v_mov_b32 v182, 0xff800000
v_mov_b32 v183, 0xff800000
v_mov_b32 v184, 0xff800000
s_mul_i32 s47, s37, 262144
s_add_u32 s47, s47, 6426624
s_lshl_b32 s48, s38, 16
s_add_u32 s47, s47, s48
s_mov_b32 s49, 0
fb_loop:
buffer_load_dwordx4 v[32:35], v5, s[8:11], s47 offen sc1
buffer_load_dwordx2 v[36:37], v170, s[8:11], s47 offen offset:1024 sc1
s_waitcnt vmcnt(0)
v_mfma_f32_32x32x16_bf16 v[72:87], v[32:35], v[8:11], 0
v_mfma_f32_32x32x8_bf16 v[72:87], v[36:37], v[12:13], v[72:87]
s_nop 11
v_max3_f32 v181, v181, v72, v73
v_max3_f32 v181, v181, v74, v75
v_max3_f32 v181, v181, v76, v77
v_max3_f32 v181, v181, v78, v79
v_max3_f32 v181, v181, v80, v81
v_max3_f32 v181, v181, v82, v83
v_max3_f32 v181, v181, v84, v85
v_max3_f32 v181, v181, v86, v87
v_mfma_f32_32x32x16_bf16 v[72:87], v[32:35], v[14:17], 0
v_mfma_f32_32x32x8_bf16 v[72:87], v[36:37], v[18:19], v[72:87]
s_nop 11
v_max3_f32 v182, v182, v72, v73
v_max3_f32 v182, v182, v74, v75
v_max3_f32 v182, v182, v76, v77
v_max3_f32 v182, v182, v78, v79
v_max3_f32 v182, v182, v80, v81
v_max3_f32 v182, v182, v82, v83
v_max3_f32 v182, v182, v84, v85
v_max3_f32 v182, v182, v86, v87
v_mfma_f32_32x32x16_bf16 v[72:87], v[32:35], v[20:23], 0
v_mfma_f32_32x32x8_bf16 v[72:87], v[36:37], v[24:25], v[72:87]
s_nop 11
v_max3_f32 v183, v183, v72, v73
v_max3_f32 v183, v183, v74, v75
v_max3_f32 v183, v183, v76, v77
v_max3_f32 v183, v183, v78, v79
v_max3_f32 v183, v183, v80, v81
v_max3_f32 v183, v183, v82, v83
v_max3_f32 v183, v183, v84, v85
v_max3_f32 v183, v183, v86, v87
v_mfma_f32_32x32x16_bf16 v[72:87], v[32:35], v[26:29], 0
v_mfma_f32_32x32x8_bf16 v[72:87], v[36:37], v[30:31], v[72:87]
s_nop 11
v_max3_f32 v184, v184, v72, v73
v_max3_f32 v184, v184, v74, v75
v_max3_f32 v184, v184, v76, v77
v_max3_f32 v184, v184, v78, v79
v_max3_f32 v184, v184, v80, v81
v_max3_f32 v184, v184, v82, v83
v_max3_f32 v184, v184, v84, v85
v_max3_f32 v184, v184, v86, v87
s_add_u32 s47, s47, 4096
s_add_u32 s49, s49, 1
s_cmp_lt_u32 s49, 16
s_cbranch_scc1 fb_loop
v_xor_b32 v171, 32, v1
v_lshlrev_b32 v171, 2, v171
ds_bpermute_b32 v172, v171, v181
s_waitcnt lgkmcnt(0)
v_max_f32 v181, v181, v172
ds_bpermute_b32 v172, v171, v182
s_waitcnt lgkmcnt(0)
v_max_f32 v182, v182, v172
ds_bpermute_b32 v172, v171, v183
s_waitcnt lgkmcnt(0)
v_max_f32 v183, v183, v172
ds_bpermute_b32 v172, v171, v184
s_waitcnt lgkmcnt(0)
v_max_f32 v184, v184, v172
v_lshlrev_b32 v171, 2, v6
s_add_u32 s40, s38, 0
s_and_b32 s40, s40, 3
s_lshl_b32 s41, s39, 2
s_add_u32 s40, s40, s41
s_lshl_b32 s40, s40, 9
s_lshl_b32 s41, s38, 7
s_add_u32 s41, s41, s40
s_add_u32 s41, s41, 114688
v_add_u32 v172, s41, v171
ds_write_b32 v172, v181
s_add_u32 s40, s38, 1
s_and_b32 s40, s40, 3
s_lshl_b32 s41, s39, 2
s_add_u32 s40, s40, s41
s_lshl_b32 s40, s40, 9
s_lshl_b32 s41, s38, 7
s_add_u32 s41, s41, s40
s_add_u32 s41, s41, 114688
v_add_u32 v172, s41, v171
ds_write_b32 v172, v182
s_add_u32 s40, s38, 2
s_and_b32 s40, s40, 3
s_lshl_b32 s41, s39, 2
s_add_u32 s40, s40, s41
s_lshl_b32 s40, s40, 9
s_lshl_b32 s41, s38, 7
s_add_u32 s41, s41, s40
s_add_u32 s41, s41, 114688
v_add_u32 v172, s41, v171
ds_write_b32 v172, v183
s_add_u32 s40, s38, 3
s_and_b32 s40, s40, 3
s_lshl_b32 s41, s39, 2
s_add_u32 s40, s40, s41
s_lshl_b32 s40, s40, 9
s_lshl_b32 s41, s38, 7
s_add_u32 s41, s41, s40
s_add_u32 s41, s41, 114688
v_add_u32 v172, s41, v171
ds_write_b32 v172, v184
s_waitcnt lgkmcnt(0)
s_barrier
s_add_u32 s40, s38, 0
s_and_b32 s40, s40, 3
s_lshl_b32 s41, s39, 2
s_add_u32 s40, s40, s41
s_lshl_b32 s40, s40, 9
s_add_u32 s40, s40, 114688
v_add_u32 v172, s40, v171
ds_read_b32 v173, v172
ds_read_b32 v174, v172 offset:128
ds_read_b32 v175, v172 offset:256
ds_read_b32 v176, v172 offset:384
s_waitcnt lgkmcnt(0)
v_max_f32 v173, v173, v174
v_max3_f32 v173, v173, v175, v176
v_sub_f32 v173, 0, v173
v_cvt_pk_bf16_f32 v174, v173, v173
v_lshlrev_b32 v175, 16, v174
v_sub_f32 v175, v173, v175
v_cvt_pk_bf16_f32 v176, v173, v175
v_cmp_eq_u32 vcc, 1, v7
s_nop 1
v_cndmask_b32 v12, v12, v176, vcc
s_add_u32 s40, s38, 1
s_and_b32 s40, s40, 3
s_lshl_b32 s41, s39, 2
s_add_u32 s40, s40, s41
s_lshl_b32 s40, s40, 9
s_add_u32 s40, s40, 114688
v_add_u32 v172, s40, v171
ds_read_b32 v173, v172
ds_read_b32 v174, v172 offset:128
ds_read_b32 v175, v172 offset:256
ds_read_b32 v176, v172 offset:384
s_waitcnt lgkmcnt(0)
v_max_f32 v173, v173, v174
v_max3_f32 v173, v173, v175, v176
v_sub_f32 v173, 0, v173
v_cvt_pk_bf16_f32 v174, v173, v173
v_lshlrev_b32 v175, 16, v174
v_sub_f32 v175, v173, v175
v_cvt_pk_bf16_f32 v176, v173, v175
v_cmp_eq_u32 vcc, 1, v7
s_nop 1
v_cndmask_b32 v18, v18, v176, vcc
s_add_u32 s40, s38, 2
s_and_b32 s40, s40, 3
s_lshl_b32 s41, s39, 2
s_add_u32 s40, s40, s41
s_lshl_b32 s40, s40, 9
s_add_u32 s40, s40, 114688
v_add_u32 v172, s40, v171
ds_read_b32 v173, v172
ds_read_b32 v174, v172 offset:128
ds_read_b32 v175, v172 offset:256
ds_read_b32 v176, v172 offset:384
s_waitcnt lgkmcnt(0)
v_max_f32 v173, v173, v174
v_max3_f32 v173, v173, v175, v176
v_sub_f32 v173, 0, v173
v_cvt_pk_bf16_f32 v174, v173, v173
v_lshlrev_b32 v175, 16, v174
v_sub_f32 v175, v173, v175
v_cvt_pk_bf16_f32 v176, v173, v175
v_cmp_eq_u32 vcc, 1, v7
s_nop 1
v_cndmask_b32 v24, v24, v176, vcc
s_add_u32 s40, s38, 3
s_and_b32 s40, s40, 3
s_lshl_b32 s41, s39, 2
s_add_u32 s40, s40, s41
s_lshl_b32 s40, s40, 9
s_add_u32 s40, s40, 114688
v_add_u32 v172, s40, v171
ds_read_b32 v173, v172
ds_read_b32 v174, v172 offset:128
ds_read_b32 v175, v172 offset:256
ds_read_b32 v176, v172 offset:384
s_waitcnt lgkmcnt(0)
v_max_f32 v173, v173, v174
v_max3_f32 v173, v173, v175, v176
v_sub_f32 v173, 0, v173
v_cvt_pk_bf16_f32 v174, v173, v173
v_lshlrev_b32 v175, 16, v174
v_sub_f32 v175, v173, v175
v_cvt_pk_bf16_f32 v176, v173, v175
v_cmp_eq_u32 vcc, 1, v7
s_nop 1
v_cndmask_b32 v30, v30, v176, vcc
s_mov_b32 s57, 1
s_barrier
s_branch att_main
layer_end:
s_add_u32 s37, s37, 1
s_cmp_lt_u32 s37, 2
s_cbranch_scc1 layer_top
s_waitcnt vmcnt(0)
s_endpgm
main_kernel_exit:
s_endpgm
.section .rodata,"a"
.p2align 6
.amdhsa_kernel prep_kernel
  .amdhsa_next_free_vgpr 144
  .amdhsa_next_free_sgpr 102
  .amdhsa_accum_offset 144
  .amdhsa_group_segment_fixed_size 0
  .amdhsa_kernarg_size 104
  .amdhsa_user_sgpr_count 2
  .amdhsa_user_sgpr_kernarg_segment_ptr 1
  .amdhsa_system_sgpr_workgroup_id_x 1
  .amdhsa_float_denorm_mode_32 3
  .amdhsa_float_denorm_mode_16_64 3
.end_amdhsa_kernel
.p2align 6
.amdhsa_kernel main_kernel
  .amdhsa_next_free_vgpr 256
  .amdhsa_next_free_sgpr 102
  .amdhsa_accum_offset 256
  .amdhsa_group_segment_fixed_size 0
  .amdhsa_kernarg_size 104
  .amdhsa_user_sgpr_count 2
  .amdhsa_user_sgpr_kernarg_segment_ptr 1
  .amdhsa_system_sgpr_workgroup_id_x 1
  .amdhsa_float_denorm_mode_32 3
  .amdhsa_float_denorm_mode_16_64 3
.end_amdhsa_kernel
```
